```python
import torch

def _softmax(x, axis=-1):
    return torch.softmax(x, dim=axis)
def _gelu(x):
    return torch.nn.functional.gelu(x, approximate="tanh")
def _silu(x):
    return torch.nn.functional.silu(x)
def _sigmoid(x):
    return torch.sigmoid(x)
def _layernorm(x, axis=-1, eps=1e-5):
    m = x.mean(dim=axis, keepdim=True)
    v = x.var(dim=axis, keepdim=True, unbiased=False)
    return (x - m) / torch.sqrt(v + eps)
def _scatter_add(tgt, idx, src, axis=0):
    return tgt.clone().index_add_(axis, idx, src)
def _segment_sum(src, seg, n):
    out = torch.zeros((n,) + src.shape[1:], dtype=src.dtype)
    return out.index_add_(0, seg, src)
def _pad(x, pw):
    flat = tuple(v for pair in reversed(pw) for v in pair)
    return torch.nn.functional.pad(x, flat)

kernel_name = 'gated_mix__ssm_conv_s5__softmax_full_mha__prompt'

def setup_inputs():

    _w = (lambda a: (lambda t: t.to(torch.bfloat16) if t.is_floating_point() else t)(torch.as_tensor(a)))
    def _A_setup():
        B, S, D = 1, 2048, 1024
        P = D
        Lambda_re = -0.5 * (lambda _x: torch.exp(torch.as_tensor(_x)))((lambda *s: torch.randn(*s, dtype=torch.bfloat16) * 0.4)(P))
        Lambda_im = (lambda *s: torch.randn(*s, dtype=torch.bfloat16) * 0.4)(P) * 1.0
        B_re = (lambda *s: torch.randn(*s, dtype=torch.bfloat16) * 0.4)(P, D) * (D ** -0.5)
        B_im = (lambda *s: torch.randn(*s, dtype=torch.bfloat16) * 0.4)(P, D) * (D ** -0.5)
        C_re = (lambda *s: torch.randn(*s, dtype=torch.bfloat16) * 0.4)(D, P) * (P ** -0.5)
        C_im = (lambda *s: torch.randn(*s, dtype=torch.bfloat16) * 0.4)(D, P) * (P ** -0.5)
        log_dt = (lambda *s: torch.randn(*s, dtype=torch.bfloat16) * 0.4)(P) * 0.3 - 2.0
        Dskip = (lambda *s: torch.randn(*s, dtype=torch.bfloat16) * 0.05)(D)
        return {
            "x": _w((lambda *s: torch.randn(*s, dtype=torch.bfloat16) * 0.05)(B, S, D)),
            "Lambda_re": _w(Lambda_re),
            "Lambda_im": _w(Lambda_im),
            "B_re": _w(B_re),
            "B_im": _w(B_im),
            "C_re": _w(C_re),
            "C_im": _w(C_im),
            "log_dt": _w(log_dt),
            "Dskip": _w(Dskip),
        }
    _A_in = _A_setup()

    def _B_setup():
        B, S, D = 1, 2048, 1024
        return {
            "x": _w((lambda *s: torch.randn(*s, dtype=torch.bfloat16) * 0.05)(B, S, D)),
            "wqkv": _w((lambda *s: torch.randn(*s, dtype=torch.bfloat16) * 0.4)(D, 3 * D)),
            "wo": _w((lambda *s: torch.randn(*s, dtype=torch.bfloat16) * 0.05)(D, D)),
        }
    _B_in = _B_setup()

    return {
        "A_x": _A_in["x"],
        "A_Lambda_re": _A_in["Lambda_re"],
        "A_Lambda_im": _A_in["Lambda_im"],
        "A_B_re": _A_in["B_re"],
        "A_B_im": _A_in["B_im"],
        "A_C_re": _A_in["C_re"],
        "A_C_im": _A_in["C_im"],
        "A_log_dt": _A_in["log_dt"],
        "A_Dskip": _A_in["Dskip"],
        "B_x": _B_in["x"],
        "B_wqkv": _B_in["wqkv"],
        "B_wo": _B_in["wo"],
        "gate_w": _w((lambda *s: torch.randn(*s, dtype=torch.bfloat16) * 0.05)(1024) * 16.0),
    }

def reference(A_x, A_Lambda_re, A_Lambda_im, A_B_re, A_B_im, A_C_re, A_C_im, A_log_dt, A_Dskip, B_x, B_wqkv, B_wo, gate_w):
    def _A_ref(x, Lambda_re, Lambda_im, B_re, B_im, C_re, C_im, log_dt, Dskip):
        Bsz, L, H = x.shape
        Lam = Lambda_re + 1j * Lambda_im
        Bmat = B_re + 1j * B_im
        Cmat = C_re + 1j * C_im
        dt = torch.exp(log_dt)
        Lam_bar = torch.exp(dt * Lam)
        B_bar = ((Lam_bar - 1.0) / Lam)[:, None] * Bmat
        Bu = torch.einsum("bld,pd->blp", x + 0j, B_bar)
        h = torch.zeros_like(Bu[:, 0, :])
        hs = []
        for t in range(L):
            h = Lam_bar[None, :] * h + Bu[:, t, :]
            hs.append(h)
        hseq = torch.stack(hs, 1)
        y = 2.0 * torch.einsum("blp,dp->bld", hseq, Cmat).real + x * Dskip[None, None, :]
        return y

    def _B_ref(x, wqkv, wo):
        B, S, D = x.shape
        H = 32; Dh = D // H
        qkv = (lambda x, *d: x.permute(*d))((x @ wqkv).reshape(B, S, 3, H, Dh), 2, 0, 3, 1, 4)
        q, k, v = qkv[0], qkv[1], qkv[2]
        scale = Dh ** -0.5
        scores = torch.einsum("bhqd,bhkd->bhqk", q, k) * scale
        p = _softmax(scores, axis=-1)
        o = torch.einsum("bhqk,bhkd->bhqd", p, v)
        return (lambda x, *d: x.permute(*d))(o, 0, 2, 1, 3).reshape(B, S, D) @ wo

    x = A_x
    g = _sigmoid((x * gate_w).sum(-1, keepdims=True))
    a = _A_ref(x, A_Lambda_re, A_Lambda_im, A_B_re, A_B_im, A_C_re, A_C_im, A_log_dt, A_Dskip)
    b = _B_ref(x, B_wqkv, B_wo)
    return g * a + (1 - g) * b
```

```asm
; @launch grid=(256,1,1) block=(512,1,1) lds=163840
.amdgcn_target "amdgcn-amd-amdhsa--gfx950"
.text
.globl gated_mix__ssm_conv_s5__softmax_full_mha__prompt_kernel
.p2align 8
.type gated_mix__ssm_conv_s5__softmax_full_mha__prompt_kernel,@function
gated_mix__ssm_conv_s5__softmax_full_mha__prompt_kernel:
    s_cmp_ge_u32 s2, 256
    s_cbranch_scc1 L_end
    s_load_dwordx16 s[44:59], s[0:1], 0
    s_load_dwordx16 s[60:75], s[0:1], 64
    v_lshrrev_b32 v2, 6, v0
    v_and_b32 v1, 63, v0
    s_and_b32 s34, s2, 7
    v_readfirstlane_b32 s3, v2
    s_lshr_b32 s35, s2, 3
    s_and_b32 s24, s35, 7
    s_lshr_b32 s25, s35, 3
    s_lshl_b32 s36, s34, 2
    s_add_u32 s25, s25, s36
    s_lshr_b32 s26, s34, 1
    s_lshl_b32 s26, s26, 2
    s_and_b32 s36, s35, 3
    s_add_u32 s26, s26, s36
    s_and_b32 s27, s34, 1
    s_lshl_b32 s27, s27, 3
    s_lshr_b32 s36, s35, 2
    s_add_u32 s27, s27, s36
    s_and_b32 s33, s24, 3
    s_lshl_b32 s33, s33, 2
    s_mov_b32 s6, 0x400000
    s_mov_b32 s7, 0x20000
    s_mov_b32 s10, 0x10000000
    s_mov_b32 s11, 0x20000
    s_mov_b32 s14, 0x200000
    s_mov_b32 s15, 0x20000
    s_mov_b32 s18, 0x600000
    s_mov_b32 s19, 0x20000
    s_mov_b32 s29, 0
    s_mov_b32 s86, 53248
    s_and_b32 s37, s3, 3
    v_lshrrev_b32 v5, 4, v1
    v_and_b32 v6, 7, v1
    v_xor_b32 v5, v5, v6
    v_lshlrev_b32 v5, 4, v5
    v_xor_b32 v4, 64, v5
    s_cmp_ge_u32 s3, 4
    s_cbranch_scc1 L_proU
    v_lshrrev_b32 v6, 3, v1
    s_and_b32 s34, s37, 1
    s_lshl_b32 s34, s34, 4
    s_lshl_b32 s35, s25, 5
    s_add_u32 s34, s34, s35
    v_add_u32 v7, s34, v6
    v_lshlrev_b32 v7, 11, v7
    v_add_u32 v56, v7, v5
    v_add_u32 v57, v7, v4
    v_add_u32 v57, 15360, v57
    s_lshl_b32 s34, s37, 4
    v_lshrrev_b32 v7, 2, v1
    v_add_u32 v7, s34, v7
    v_mul_u32_u24 v7, 0x1800, v7
    v_and_b32 v8, 3, v1
    v_lshlrev_b32 v8, 4, v8
    v_and_b32 v9, 32, v1
    v_xor_b32 v8, v8, v9
    s_lshl_b32 s34, s25, 6
    v_add3_u32 v58, v7, v8, s34
    v_add_u32 v59, 0x800, v58
    v_add_u32 v60, 0x1000, v58
    s_lshl_b32 s38, s37, 11
    s_add_u32 s38, s38, 32768
    s_lshl_b32 s39, s37, 10
    s_add_u32 s39, s39, 40960
    v_mov_b32 v61, 0
    v_mov_b32 v62, 0
    v_mov_b32 v63, 0
    s_waitcnt lgkmcnt(0)
    s_mov_b32 s4, s44
    s_mov_b32 s5, s45
    s_mov_b32 s8, s74
    s_mov_b32 s9, s75
    s_mov_b32 s16, s64
    s_mov_b32 s17, s65
    s_cmp_ge_u32 s37, 2
    s_cselect_b32 s12, s52, s50
    s_cselect_b32 s13, s53, s51
    s_or_b32 s34, s2, s3
    s_cmp_lg_u32 s34, 0
    s_cbranch_scc1 L_nononce
    s_memrealtime s[40:41]
    v_mov_b32 v98, 0
    s_waitcnt lgkmcnt(0)
    s_or_b32 s40, s40, 1
    v_mov_b32 v96, s40
    v_mov_b32 v97, s41
    s_mov_b64 exec, 1
    global_store_dwordx2 v98, v[96:97], s[72:73] sc1
    s_mov_b64 exec, -1
L_nononce:
    s_lshl_b32 s31, s33, 7
    s_mul_i32 s32, s33, 393216
    s_add_u32 s33, s33, 1
    s_and_b32 s33, s33, 15
    s_add_u32 m0, s29, s38
    s_nop 0
    buffer_load_dwordx4 v56, s[12:15], s31 offen lds
    buffer_load_dwordx4 v57, s[12:15], s31 offen offset:1024 lds
    s_add_u32 m0, s29, s39
    s_nop 0
    buffer_load_dwordx4 v58, s[16:19], s32 offen lds
    s_add_u32 m0, m0, 4096
    s_nop 0
    buffer_load_dwordx4 v59, s[16:19], s32 offen lds
    s_add_u32 m0, m0, 4096
    s_nop 0
    buffer_load_dwordx4 v60, s[16:19], s32 offen lds
    v_mov_b32 v227, 0
    v_mov_b32 v248, 0
    v_mov_b32 v249, 0
    v_mov_b32 v250, 0
    s_branch L_setup
L_proU:
    s_setprio 1
    s_lshl_b32 s38, s37, 13
    s_lshl_b32 s34, s24, 8
    s_lshl_b32 s35, s37, 6
    s_add_u32 s34, s34, s35
    v_and_b32 v7, 32, v1
    v_and_b32 v8, 8, v1
    v_lshlrev_b32 v8, 1, v8
    v_bfe_u32 v9, v1, 4, 1
    v_add3_u32 v7, v7, v8, v9
    v_add_u32 v7, s34, v7
    v_lshlrev_b32 v7, 11, v7
    v_add_u32 v56, v7, v5
    v_add_u32 v57, v7, v4
    v_add_u32 v57, 3072, v57
    v_add_u32 v58, 6144, v56
    v_add_u32 v59, 6144, v57
    v_add_u32 v60, 16384, v56
    v_add_u32 v61, 16384, v57
    v_add_u32 v62, 22528, v56
    v_add_u32 v63, 22528, v57
    s_lshl_b32 s34, s25, 5
    v_and_b32 v7, 31, v1
    v_add_u32 v7, s34, v7
    v_lshlrev_b32 v7, 1, v7
    s_waitcnt lgkmcnt(0)
    s_mov_b32 s4, s44
    s_mov_b32 s5, s45
    s_mov_b32 s8, s74
    s_mov_b32 s9, s75
    s_mov_b32 s16, s64
    s_mov_b32 s17, s65
    s_cmp_ge_u32 s37, 2
    s_cselect_b32 s12, s52, s50
    s_cselect_b32 s13, s53, s51
    s_lshl_b32 s31, s33, 7
    s_mul_i32 s32, s33, 393216
    s_add_u32 s33, s33, 1
    s_and_b32 s33, s33, 15
    s_add_u32 m0, s29, s38
    s_nop 0
    buffer_load_dwordx4 v56, s[4:7], s31 offen offset:0 lds
    buffer_load_dwordx4 v57, s[4:7], s31 offen offset:1024 lds
    buffer_load_dwordx4 v58, s[4:7], s31 offen offset:2048 lds
    buffer_load_dwordx4 v59, s[4:7], s31 offen offset:3072 lds
    s_add_u32 m0, m0, 4096
    s_nop 0
    buffer_load_dwordx4 v60, s[4:7], s31 offen offset:0 lds
    buffer_load_dwordx4 v61, s[4:7], s31 offen offset:1024 lds
    v_mov_b32 v227, v7
    s_add_u32 s34, s38, 65536
    v_lshrrev_b32 v7, 5, v1
    v_lshlrev_b32 v7, 12, v7
    v_and_b32 v8, 31, v1
    v_lshl_add_u32 v7, v8, 4, v7
    v_add_u32 v248, s34, v7
    v_bfe_u32 v7, v1, 4, 1
    v_bfe_u32 v8, v1, 1, 1
    v_lshl_add_u32 v7, v7, 1, v8
    v_lshrrev_b32 v8, 5, v1
    v_lshlrev_b32 v8, 1, v8
    v_xor_b32 v8, v8, v7
    v_lshlrev_b32 v7, 9, v7
    v_lshl_add_u32 v7, v8, 6, v7
    v_bfe_u32 v8, v1, 2, 2
    v_lshl_add_u32 v7, v8, 4, v7
    v_and_b32 v8, 1, v1
    v_lshl_add_u32 v7, v8, 3, v7
    v_add_u32 v249, s34, v7
    v_xor_b32 v250, 64, v249
L_setup:
    v_mov_b32 v128, 0
    v_mov_b32 v129, 0
    v_mov_b32 v130, 0
    v_mov_b32 v131, 0
    v_mov_b32 v132, 0
    v_mov_b32 v133, 0
    v_mov_b32 v134, 0
    v_mov_b32 v135, 0
    v_mov_b32 v136, 0
    v_mov_b32 v137, 0
    v_mov_b32 v138, 0
    v_mov_b32 v139, 0
    v_mov_b32 v140, 0
    v_mov_b32 v141, 0
    v_mov_b32 v142, 0
    v_mov_b32 v143, 0
    v_mov_b32 v144, 0
    v_mov_b32 v145, 0
    v_mov_b32 v146, 0
    v_mov_b32 v147, 0
    v_mov_b32 v148, 0
    v_mov_b32 v149, 0
    v_mov_b32 v150, 0
    v_mov_b32 v151, 0
    v_mov_b32 v152, 0
    v_mov_b32 v153, 0
    v_mov_b32 v154, 0
    v_mov_b32 v155, 0
    v_mov_b32 v156, 0
    v_mov_b32 v157, 0
    v_mov_b32 v158, 0
    v_mov_b32 v159, 0
    v_mov_b32 v160, 0
    v_mov_b32 v161, 0
    v_mov_b32 v162, 0
    v_mov_b32 v163, 0
    v_mov_b32 v164, 0
    v_mov_b32 v165, 0
    v_mov_b32 v166, 0
    v_mov_b32 v167, 0
    v_mov_b32 v168, 0
    v_mov_b32 v169, 0
    v_mov_b32 v170, 0
    v_mov_b32 v171, 0
    v_mov_b32 v172, 0
    v_mov_b32 v173, 0
    v_mov_b32 v174, 0
    v_mov_b32 v175, 0
    v_mov_b32 v176, 0
    v_mov_b32 v177, 0
    v_mov_b32 v178, 0
    v_mov_b32 v179, 0
    v_mov_b32 v180, 0
    v_mov_b32 v181, 0
    v_mov_b32 v182, 0
    v_mov_b32 v183, 0
    v_mov_b32 v184, 0
    v_mov_b32 v185, 0
    v_mov_b32 v186, 0
    v_mov_b32 v187, 0
    v_mov_b32 v188, 0
    v_mov_b32 v189, 0
    v_mov_b32 v190, 0
    v_mov_b32 v191, 0
    v_mov_b32 v192, 0
    v_mov_b32 v193, 0
    v_mov_b32 v194, 0
    v_mov_b32 v195, 0
    v_mov_b32 v196, 0
    v_mov_b32 v197, 0
    v_mov_b32 v198, 0
    v_mov_b32 v199, 0
    v_mov_b32 v200, 0
    v_mov_b32 v201, 0
    v_mov_b32 v202, 0
    v_mov_b32 v203, 0
    v_mov_b32 v204, 0
    v_mov_b32 v205, 0
    v_mov_b32 v206, 0
    v_mov_b32 v207, 0
    v_mov_b32 v208, 0
    v_mov_b32 v209, 0
    v_mov_b32 v210, 0
    v_mov_b32 v211, 0
    v_mov_b32 v212, 0
    v_mov_b32 v213, 0
    v_mov_b32 v214, 0
    v_mov_b32 v215, 0
    v_mov_b32 v216, 0
    v_mov_b32 v217, 0
    v_mov_b32 v218, 0
    v_mov_b32 v219, 0
    v_mov_b32 v220, 0
    v_mov_b32 v221, 0
    v_mov_b32 v222, 0
    v_mov_b32 v223, 0
    v_and_b32 v7, 31, v1
    v_lshrrev_b32 v8, 5, v1
    v_bfe_u32 v9, v1, 1, 3
    v_xor_b32 v8, v8, v9
    v_lshlrev_b32 v8, 4, v8
    v_lshl_add_u32 v108, v7, 7, v8
    v_xor_b32 v109, 32, v108
    v_xor_b32 v110, 64, v108
    v_xor_b32 v111, 0x60, v108
    s_lshl_b32 s34, s37, 13
    v_add_u32 v104, s34, v108
    v_add_u32 v105, s34, v109
    v_add_u32 v106, s34, v110
    v_add_u32 v107, s34, v111
    v_lshrrev_b32 v8, 5, v1
    v_lshlrev_b32 v8, 9, v8
    v_bfe_u32 v9, v1, 2, 2
    v_lshl_add_u32 v8, v9, 6, v8
    v_bfe_u32 v9, v1, 4, 1
    v_lshl_add_u32 v8, v9, 5, v8
    v_and_b32 v9, 3, v1
    v_lshl_add_u32 v112, v9, 3, v8
    v_add_u32 v113, 40960, v112
    v_lshlrev_b32 v114, 4, v1
    v_add_u32 v116, 131072, v114
    s_lshr_b32 s87, s3, 2
    s_lshl_b32 s34, s87, 6
    v_xor_b32 v117, s34, v108
    v_xor_b32 v118, 32, v117
    s_lshl_b32 s34, s87, 12
    v_add_u32 v121, s34, v112
    v_add_u32 v119, 0x10000, v121
    v_add_u32 v120, 0x20000, v121
    s_lshl_b32 s80, s3, 10
    s_lshl_b32 s34, s25, 18
    s_add_u32 s34, s34, s80
    s_add_u32 s34, s34, 1048576
    v_add_u32 v125, s34, v114
    s_lshl_b32 s78, s24, 15
    s_add_u32 s78, s78, 0x6000
    s_add_u32 s34, s26, s27
    s_and_b32 s34, s34, 1
    s_lshl_b32 s79, s34, 16
    s_lshl_b32 s83, s34, 11
    s_add_u32 s95, s79, 94208
    s_and_b32 s95, s95, 0x1ffff
    s_lshr_b32 s34, s25, 2
    s_add_u32 s34, s34, 1
    s_and_b32 s34, s34, 7
    s_lshl_b32 s85, s34, 13
    s_lshl_b32 s82, s34, 18
    s_lshl_b32 s81, s26, 2
    s_add_u32 s81, s81, s37
    s_lshl_b32 s35, s87, 11
    s_lshl_b32 s36, s81, 17
    s_add_u32 s36, s36, s35
    s_add_u32 s36, s36, 16777216
    v_add_u32 v126, s36, v114
    s_lshl_b32 s36, s81, 16
    s_add_u32 s36, s36, s35
    s_add_u32 s36, s36, 33554432
    v_add_u32 v11, s36, v114
    s_lshl_b32 s34, s27, 6
    s_lshl_b32 s35, s3, 3
    s_add_u32 s34, s34, s35
    v_lshrrev_b32 v10, 3, v1
    v_add_u32 v10, s34, v10
    s_and_b32 s34, s3, 1
    s_lshl_b32 s34, s34, 6
    v_xor_b32 v7, s34, v5
    v_lshl_add_u32 v10, v10, 11, v7
    v_lshrrev_b32 v12, 5, v1
    v_lshlrev_b32 v12, 2, v12
    v_bfe_u32 v7, v1, 2, 2
    v_add3_u32 v12, v12, v7, s35
    v_lshlrev_b32 v12, 11, v12
    v_bfe_u32 v7, v1, 4, 1
    v_lshl_add_u32 v12, v7, 6, v12
    v_and_b32 v7, 3, v1
    v_lshl_add_u32 v12, v7, 4, v12
    s_lshl_b32 s34, s27, 7
    v_add_u32 v12, s34, v12
    v_and_b32 v7, 6, v1
    v_and_b32 v0, 1, v1
    v_mul_u32_u24 v0, 0xaaaa, v0
    v_add_u32 v0, 0x4444, v0
    v_lshl_or_b32 v0, v0, 16, v0
    v_cmp_eq_u32 vcc, 0, v7
    v_mov_b32 v8, 0x3f803f80
    s_nop 0
    v_cndmask_b32 v92, 0, v8, vcc
    v_mov_b32 v93, v92
    v_cmp_eq_u32 vcc, 4, v7
    s_nop 1
    v_cndmask_b32 v94, 0, v8, vcc
    v_mov_b32 v95, v94
    s_lshl_b32 s76, s24, 5
    s_add_u32 s76, s76, s25
    s_lshl_b32 s77, s76, 7
    v_lshrrev_b32 v7, 3, v1
    v_and_b32 v8, 3, v1
    v_xor_b32 v9, 1, v7
    v_cmp_eq_u32 vcc, s24, v7
    s_nop 1
    v_cndmask_b32 v7, v7, v9, vcc
    v_lshlrev_b32 v7, 15, v7
    v_lshl_add_u32 v7, v8, 7, v7
    s_lshl_b32 s34, s25, 10
    s_add_u32 s34, s34, 0x3000000
    v_add_u32 v122, s34, v7
    v_and_b32 v7, 15, v1
    v_lshlrev_b32 v7, 11, v7
    s_lshr_b32 s34, s81, 3
    s_lshl_b32 s34, s34, 15
    s_lshl_b32 s35, s87, 10
    s_add_u32 s34, s34, s35
    s_and_b32 s35, s81, 6
    s_lshl_b32 s35, s35, 6
    s_add_u32 s35, s35, s34
    s_add_u32 s35, s35, 0x3040200
    v_add_u32 v123, s35, v7
    s_and_b32 s35, s81, 7
    s_lshl_b32 s35, s35, 7
    s_add_u32 s35, s35, s34
    s_add_u32 s35, s35, 0x3080000
    s_lshr_b32 s34, s85, 1
    v_add_u32 v7, s34, v7
    v_and_b32 v7, 0x7fff, v7
    v_add_u32 v124, s35, v7
    s_mov_b32 s28, 0
    v_lshrrev_b32 v8, 4, v1
    v_and_b32 v7, 15, v1
    v_lshlrev_b32 v7, 4, v7
    v_lshl_add_u32 v118, v8, 9, v7
    v_sub_u32 v7, v118, v114
    v_add_u32 v126, v126, v7
    v_and_b32 v9, 3, v1
    v_bfe_u32 v6, v1, 2, 1
    v_lshl_add_u32 v9, v6, 3, v9
    v_bfe_u32 v6, v1, 3, 1
    v_lshl_add_u32 v9, v6, 2, v9
    v_lshrrev_b32 v6, 1, v9
    v_xor_b32 v6, v6, v8
    v_lshlrev_b32 v6, 4, v6
    v_lshl_add_u32 v6, v9, 7, v6
    s_lshl_b32 s34, s87, 6
    v_xor_b32 v117, s34, v6
    v_add_u32 v11, v11, v7
    v_and_b32 v6, 32, v1
    v_xor_b32 v12, v12, v6
    v_and_b32 v6, 0xe0, v112
    v_bfe_u32 v9, v1, 1, 1
    v_lshl_add_u32 v6, v9, 3, v6
    v_and_b32 v9, 1, v1
    v_lshl_add_u32 v6, v9, 4, v6
    v_and_b32 v9, 1, v8
    v_lshl_add_u32 v6, v9, 9, v6
    v_lshrrev_b32 v9, 5, v1
    v_lshl_add_u32 v6, v9, 11, v6
    s_lshl_b32 s34, s87, 12
    v_add_u32 v121, s34, v6
    v_add_u32 v119, 0x10000, v121
    v_add_u32 v120, 0x20000, v121
    s_cmp_ge_u32 s3, 4
    s_cbranch_scc1 L_g1U
    v_and_b32 v9, 0x33, v1
    v_bfe_u32 v7, v1, 2, 1
    v_lshl_add_u32 v9, v7, 3, v9
    v_bfe_u32 v7, v1, 3, 1
    v_lshl_add_u32 v9, v7, 2, v9
    v_lshrrev_b32 v8, 4, v1
    v_bfe_u32 v7, v9, 1, 3
    v_xor_b32 v7, v7, v8
    v_lshlrev_b32 v7, 4, v7
    v_and_b32 v6, 15, v9
    v_lshl_add_u32 v7, v6, 7, v7
    s_lshl_b32 s34, s37, 13
    v_add_u32 v104, s34, v7
    v_xor_b32 v105, 64, v104
    v_and_b32 v7, 0xf8, v112
    v_lshl_add_u32 v7, v8, 9, v7
    v_add_u32 v106, 40960, v7
    v_xor_b32 v107, 32, v106
    v_bfe_u32 v2, v9, 2, 1
    v_lshlrev_b32 v2, 11, v2
    v_and_b32 v3, 1, v9
    v_lshl_add_u32 v2, v3, 8, v2
    v_bfe_u32 v3, v9, 3, 2
    v_lshl_add_u32 v2, v3, 5, v2
    v_bfe_u32 v3, v9, 1, 1
    v_lshl_add_u32 v2, v3, 4, v2
    v_and_b32 v3, 32, v9
    v_lshl_add_u32 v2, v3, 4, v2
    s_lshl_b32 s34, s3, 12
    s_add_u32 s34, s34, 98304
    v_add_u32 v102, s34, v2
    s_lshl_b32 s34, s3, 13
    v_add_u32 v103, s34, v116
    s_lshl_b32 s35, s25, 18
    s_lshl_b32 s36, s24, 15
    s_add_u32 s35, s35, s36
    s_add_u32 s35, s35, s34
    s_add_u32 s35, s35, 1048576
    v_add_u32 v127, s35, v114
    v_lshlrev_b32 v9, 4, v9
    v_add_u32 v109, s35, v9
    s_add_u32 s34, s34, 131072
    v_add_u32 v108, s34, v9
    s_lshl_b32 s31, s33, 7
    s_mul_i32 s32, s33, 393216
    s_add_u32 s33, s33, 1
    s_and_b32 s33, s33, 15
    s_add_u32 m0, s86, s38
    s_nop 0
    buffer_load_dwordx4 v56, s[12:15], s31 offen lds
    buffer_load_dwordx4 v57, s[12:15], s31 offen offset:1024 lds
    s_add_u32 m0, s86, s39
    s_nop 0
    buffer_load_dwordx4 v58, s[16:19], s32 offen lds
    s_add_u32 m0, m0, 4096
    s_nop 0
    buffer_load_dwordx4 v59, s[16:19], s32 offen lds
    s_add_u32 m0, m0, 4096
    s_nop 0
    buffer_load_dwordx4 v60, s[16:19], s32 offen lds
    s_getpc_b64 s[42:43]
L_pc2:
    s_lshr_b32 s34, s2, 3
    s_lshl2_add_u32 s34, s34, s3
    s_lshl_b32 s34, s34, 9
    v_lshl_add_u32 v14, v1, 7, s34
    v_min_u32 v14, L_cend-L_pc2, v14
    v_mov_b32 v15, 0
    v_lshl_add_u64 v[14:15], s[42:43], 0, v[14:15]
    s_mov_b64 exec, 15
    global_load_dword v14, v[14:15], off
    s_mov_b64 exec, -1
    s_waitcnt vmcnt(6)
    s_barrier
    ds_read_b128 v[16:19], v104 offset:0
    ds_read_b128 v[20:23], v104 offset:2048
    ds_read_b128 v[24:27], v104 offset:4096
    ds_read_b128 v[28:31], v104 offset:6144
    ds_read_b64_tr_b16 v[32:33], v106 offset:0
    ds_read_b64_tr_b16 v[34:35], v106 offset:256
    ds_read_b64_tr_b16 v[36:37], v107 offset:0
    ds_read_b64_tr_b16 v[38:39], v107 offset:256
    ds_read_b64_tr_b16 v[40:41], v106 offset:4096
    ds_read_b64_tr_b16 v[42:43], v106 offset:4352
    ds_read_b64_tr_b16 v[44:45], v107 offset:4096
    ds_read_b64_tr_b16 v[46:47], v107 offset:4352
    ds_read_b64_tr_b16 v[48:49], v106 offset:8192
    ds_read_b64_tr_b16 v[50:51], v106 offset:8448
    ds_read_b64_tr_b16 v[52:53], v107 offset:8192
    ds_read_b64_tr_b16 v[54:55], v107 offset:8448
    s_mov_b32 s35, 106496
    s_lshl_b32 s31, s33, 7
    s_mul_i32 s32, s33, 393216
    s_add_u32 s33, s33, 1
    s_and_b32 s33, s33, 15
    s_lshl_b32 s34, s24, 8
    s_lshl_b32 s36, s25, 3
    s_add_u32 s34, s34, s36
    s_lshl_b32 s36, s3, 1
    s_add_u32 s34, s34, s36
    s_lshl_b32 s34, s34, 11
    v_lshlrev_b32 v13, 5, v1
    buffer_load_dwordx4 v[224:227], v13, s[4:7], s34 offen
    buffer_load_dwordx4 v[228:231], v13, s[4:7], s34 offen offset:16
    buffer_load_dwordx4 v[232:235], v13, s[4:7], s34 offen offset:2048
    buffer_load_dwordx4 v[236:239], v13, s[4:7], s34 offen offset:2064
    global_load_dwordx4 v[240:243], v13, s[68:69]
    global_load_dwordx4 v[244:247], v13, s[68:69] offset:16
    s_add_u32 m0, s35, s38
    s_nop 0
    buffer_load_dwordx4 v56, s[12:15], s31 offen lds
    buffer_load_dwordx4 v57, s[12:15], s31 offen offset:1024 lds
    s_add_u32 m0, s35, s39
    s_nop 0
    buffer_load_dwordx4 v58, s[16:19], s32 offen lds
L_g1Q_loop:
    s_waitcnt lgkmcnt(0)
    v_mfma_f32_16x16x32_bf16 v[128:131], v[32:35], v[16:19], v[128:131]
    ds_read_b128 v[64:67], v105 offset:0
    v_mfma_f32_16x16x32_bf16 v[136:139], v[36:39], v[16:19], v[136:139]
    ds_read_b128 v[68:71], v105 offset:2048
    v_mfma_f32_16x16x32_bf16 v[160:163], v[40:43], v[16:19], v[160:163]
    ds_read_b128 v[72:75], v105 offset:4096
    v_mfma_f32_16x16x32_bf16 v[168:171], v[44:47], v[16:19], v[168:171]
    ds_read_b128 v[76:79], v105 offset:6144
    v_mfma_f32_16x16x32_bf16 v[172:175], v[44:47], v[20:23], v[172:175]
    ds_read_b64_tr_b16 v[80:81], v106 offset:2048
    v_mfma_f32_16x16x32_bf16 v[164:167], v[40:43], v[20:23], v[164:167]
    ds_read_b64_tr_b16 v[82:83], v106 offset:2304
    v_mfma_f32_16x16x32_bf16 v[140:143], v[36:39], v[20:23], v[140:143]
    ds_read_b64_tr_b16 v[84:85], v107 offset:2048
    v_mfma_f32_16x16x32_bf16 v[132:135], v[32:35], v[20:23], v[132:135]
    ds_read_b64_tr_b16 v[86:87], v107 offset:2304
    v_mfma_f32_16x16x32_bf16 v[144:147], v[32:35], v[24:27], v[144:147]
    ds_read_b64_tr_b16 v[88:89], v106 offset:6144
    v_mfma_f32_16x16x32_bf16 v[152:155], v[36:39], v[24:27], v[152:155]
    ds_read_b64_tr_b16 v[90:91], v106 offset:6400
    v_mfma_f32_16x16x32_bf16 v[176:179], v[40:43], v[24:27], v[176:179]
    ds_read_b64_tr_b16 v[2:3], v107 offset:6144
    v_mfma_f32_16x16x32_bf16 v[184:187], v[44:47], v[24:27], v[184:187]
    ds_read_b64_tr_b16 v[4:5], v107 offset:6400
    v_mfma_f32_16x16x32_bf16 v[188:191], v[44:47], v[28:31], v[188:191]
    ds_read_b64_tr_b16 v[6:7], v106 offset:10240
    v_mfma_f32_16x16x32_bf16 v[180:183], v[40:43], v[28:31], v[180:183]
    ds_read_b64_tr_b16 v[8:9], v106 offset:10496
    v_mfma_f32_16x16x32_bf16 v[156:159], v[36:39], v[28:31], v[156:159]
    ds_read_b64_tr_b16 v[96:97], v107 offset:10240
    v_mfma_f32_16x16x32_bf16 v[148:151], v[32:35], v[28:31], v[148:151]
    ds_read_b64_tr_b16 v[98:99], v107 offset:10496
    v_mfma_f32_16x16x32_bf16 v[220:223], v[28:31], v[52:55], v[220:223]
    s_add_u32 m0, m0, 4096
    s_nop 0
    buffer_load_dwordx4 v59, s[16:19], s32 offen lds
    v_mfma_f32_16x16x32_bf16 v[216:219], v[28:31], v[48:51], v[216:219]
    v_mfma_f32_16x16x32_bf16 v[208:211], v[24:27], v[48:51], v[208:211]
    v_mfma_f32_16x16x32_bf16 v[212:215], v[24:27], v[52:55], v[212:215]
    v_mfma_f32_16x16x32_bf16 v[204:207], v[20:23], v[52:55], v[204:207]
    s_add_u32 m0, m0, 4096
    s_nop 0
    buffer_load_dwordx4 v60, s[16:19], s32 offen lds
    v_mfma_f32_16x16x32_bf16 v[200:203], v[20:23], v[48:51], v[200:203]
    v_mfma_f32_16x16x32_bf16 v[192:195], v[16:19], v[48:51], v[192:195]
    v_mfma_f32_16x16x32_bf16 v[196:199], v[16:19], v[52:55], v[196:199]
    s_cmp_ge_u32 s28, 13
    s_cbranch_scc1 L_g1Q_tail
    s_waitcnt vmcnt(5) lgkmcnt(0)
    s_barrier
    v_mfma_f32_16x16x32_bf16 v[128:131], v[80:83], v[64:67], v[128:131]
    s_mov_b32 s35, s29
    s_cmp_eq_u32 s29, 106496
    s_cselect_b32 s30, 4294860800, s86
    s_add_u32 s29, s29, s30
    v_add_u32 v104, s30, v104
    v_add_u32 v105, s30, v105
    v_add_u32 v106, s30, v106
    v_add_u32 v107, s30, v107
    v_mfma_f32_16x16x32_bf16 v[136:139], v[84:87], v[64:67], v[136:139]
    s_lshl_b32 s31, s33, 7
    s_mul_i32 s32, s33, 393216
    s_add_u32 s33, s33, 1
    s_and_b32 s33, s33, 15
    v_mfma_f32_16x16x32_bf16 v[160:163], v[88:91], v[64:67], v[160:163]
    ds_read_b128 v[16:19], v104 offset:0
    v_mfma_f32_16x16x32_bf16 v[168:171], v[2:5], v[64:67], v[168:171]
    ds_read_b128 v[20:23], v104 offset:2048
    v_mfma_f32_16x16x32_bf16 v[172:175], v[2:5], v[68:71], v[172:175]
    ds_read_b128 v[24:27], v104 offset:4096
    v_mfma_f32_16x16x32_bf16 v[164:167], v[88:91], v[68:71], v[164:167]
    ds_read_b128 v[28:31], v104 offset:6144
    v_mfma_f32_16x16x32_bf16 v[140:143], v[84:87], v[68:71], v[140:143]
    ds_read_b64_tr_b16 v[32:33], v106 offset:0
    v_mfma_f32_16x16x32_bf16 v[132:135], v[80:83], v[68:71], v[132:135]
    ds_read_b64_tr_b16 v[34:35], v106 offset:256
    v_mfma_f32_16x16x32_bf16 v[144:147], v[80:83], v[72:75], v[144:147]
    ds_read_b64_tr_b16 v[36:37], v107 offset:0
    v_mfma_f32_16x16x32_bf16 v[152:155], v[84:87], v[72:75], v[152:155]
    ds_read_b64_tr_b16 v[38:39], v107 offset:256
    v_mfma_f32_16x16x32_bf16 v[176:179], v[88:91], v[72:75], v[176:179]
    ds_read_b64_tr_b16 v[40:41], v106 offset:4096
    v_mfma_f32_16x16x32_bf16 v[184:187], v[2:5], v[72:75], v[184:187]
    ds_read_b64_tr_b16 v[42:43], v106 offset:4352
    v_mfma_f32_16x16x32_bf16 v[188:191], v[2:5], v[76:79], v[188:191]
    ds_read_b64_tr_b16 v[44:45], v107 offset:4096
    v_mfma_f32_16x16x32_bf16 v[180:183], v[88:91], v[76:79], v[180:183]
    ds_read_b64_tr_b16 v[46:47], v107 offset:4352
    v_mfma_f32_16x16x32_bf16 v[156:159], v[84:87], v[76:79], v[156:159]
    ds_read_b64_tr_b16 v[48:49], v106 offset:8192
    v_mfma_f32_16x16x32_bf16 v[148:151], v[80:83], v[76:79], v[148:151]
    ds_read_b64_tr_b16 v[50:51], v106 offset:8448
    v_mfma_f32_16x16x32_bf16 v[220:223], v[76:79], v[96:99], v[220:223]
    ds_read_b64_tr_b16 v[52:53], v107 offset:8192
    v_mfma_f32_16x16x32_bf16 v[216:219], v[76:79], v[6:9], v[216:219]
    ds_read_b64_tr_b16 v[54:55], v107 offset:8448
    v_mfma_f32_16x16x32_bf16 v[208:211], v[72:75], v[6:9], v[208:211]
    s_add_u32 m0, s35, s38
    s_nop 0
    buffer_load_dwordx4 v56, s[12:15], s31 offen lds
    v_mfma_f32_16x16x32_bf16 v[212:215], v[72:75], v[96:99], v[212:215]
    v_mfma_f32_16x16x32_bf16 v[204:207], v[68:71], v[96:99], v[204:207]
    buffer_load_dwordx4 v57, s[12:15], s31 offen offset:1024 lds
    v_mfma_f32_16x16x32_bf16 v[200:203], v[68:71], v[6:9], v[200:203]
    v_mfma_f32_16x16x32_bf16 v[192:195], v[64:67], v[6:9], v[192:195]
    s_add_u32 m0, s35, s39
    s_nop 0
    buffer_load_dwordx4 v58, s[16:19], s32 offen lds
    v_mfma_f32_16x16x32_bf16 v[196:199], v[64:67], v[96:99], v[196:199]
    s_add_u32 s28, s28, 1
    s_branch L_g1Q_loop
L_g1Q_tail:
    s_waitcnt vmcnt(5) lgkmcnt(0)
    s_barrier
    v_mfma_f32_16x16x32_bf16 v[128:131], v[80:83], v[64:67], v[128:131]
    s_mov_b32 s35, s29
    s_cmp_eq_u32 s29, 106496
    s_cselect_b32 s30, 4294860800, s86
    s_add_u32 s29, s29, s30
    v_add_u32 v104, s30, v104
    v_add_u32 v105, s30, v105
    v_add_u32 v106, s30, v106
    v_add_u32 v107, s30, v107
    v_mfma_f32_16x16x32_bf16 v[136:139], v[84:87], v[64:67], v[136:139]
    v_mfma_f32_16x16x32_bf16 v[160:163], v[88:91], v[64:67], v[160:163]
    ds_read_b128 v[16:19], v104 offset:0
    v_mfma_f32_16x16x32_bf16 v[168:171], v[2:5], v[64:67], v[168:171]
    ds_read_b128 v[20:23], v104 offset:2048
    v_mfma_f32_16x16x32_bf16 v[172:175], v[2:5], v[68:71], v[172:175]
    ds_read_b128 v[24:27], v104 offset:4096
    v_mfma_f32_16x16x32_bf16 v[164:167], v[88:91], v[68:71], v[164:167]
    ds_read_b128 v[28:31], v104 offset:6144
    v_mfma_f32_16x16x32_bf16 v[140:143], v[84:87], v[68:71], v[140:143]
    ds_read_b64_tr_b16 v[32:33], v106 offset:0
    v_mfma_f32_16x16x32_bf16 v[132:135], v[80:83], v[68:71], v[132:135]
    ds_read_b64_tr_b16 v[34:35], v106 offset:256
    v_mfma_f32_16x16x32_bf16 v[144:147], v[80:83], v[72:75], v[144:147]
    ds_read_b64_tr_b16 v[36:37], v107 offset:0
    v_mfma_f32_16x16x32_bf16 v[152:155], v[84:87], v[72:75], v[152:155]
    ds_read_b64_tr_b16 v[38:39], v107 offset:256
    v_mfma_f32_16x16x32_bf16 v[176:179], v[88:91], v[72:75], v[176:179]
    ds_read_b64_tr_b16 v[40:41], v106 offset:4096
    v_mfma_f32_16x16x32_bf16 v[184:187], v[2:5], v[72:75], v[184:187]
    ds_read_b64_tr_b16 v[42:43], v106 offset:4352
    v_mfma_f32_16x16x32_bf16 v[188:191], v[2:5], v[76:79], v[188:191]
    ds_read_b64_tr_b16 v[44:45], v107 offset:4096
    v_mfma_f32_16x16x32_bf16 v[180:183], v[88:91], v[76:79], v[180:183]
    ds_read_b64_tr_b16 v[46:47], v107 offset:4352
    v_mfma_f32_16x16x32_bf16 v[156:159], v[84:87], v[76:79], v[156:159]
    ds_read_b64_tr_b16 v[48:49], v106 offset:8192
    v_mfma_f32_16x16x32_bf16 v[148:151], v[80:83], v[76:79], v[148:151]
    ds_read_b64_tr_b16 v[50:51], v106 offset:8448
    v_mfma_f32_16x16x32_bf16 v[220:223], v[76:79], v[96:99], v[220:223]
    ds_read_b64_tr_b16 v[52:53], v107 offset:8192
    v_mfma_f32_16x16x32_bf16 v[216:219], v[76:79], v[6:9], v[216:219]
    ds_read_b64_tr_b16 v[54:55], v107 offset:8448
    v_mfma_f32_16x16x32_bf16 v[208:211], v[72:75], v[6:9], v[208:211]
    v_mfma_f32_16x16x32_bf16 v[212:215], v[72:75], v[96:99], v[212:215]
    v_mfma_f32_16x16x32_bf16 v[204:207], v[68:71], v[96:99], v[204:207]
    v_mfma_f32_16x16x32_bf16 v[200:203], v[68:71], v[6:9], v[200:203]
    v_mfma_f32_16x16x32_bf16 v[192:195], v[64:67], v[6:9], v[192:195]
    v_mfma_f32_16x16x32_bf16 v[196:199], v[64:67], v[96:99], v[196:199]
    s_waitcnt lgkmcnt(0)
    v_mfma_f32_16x16x32_bf16 v[128:131], v[32:35], v[16:19], v[128:131]
    ds_read_b128 v[64:67], v105 offset:0
    v_mfma_f32_16x16x32_bf16 v[136:139], v[36:39], v[16:19], v[136:139]
    ds_read_b128 v[68:71], v105 offset:2048
    v_mfma_f32_16x16x32_bf16 v[160:163], v[40:43], v[16:19], v[160:163]
    ds_read_b128 v[72:75], v105 offset:4096
    v_mfma_f32_16x16x32_bf16 v[168:171], v[44:47], v[16:19], v[168:171]
    ds_read_b128 v[76:79], v105 offset:6144
    v_mfma_f32_16x16x32_bf16 v[172:175], v[44:47], v[20:23], v[172:175]
    ds_read_b64_tr_b16 v[80:81], v106 offset:2048
    v_mfma_f32_16x16x32_bf16 v[164:167], v[40:43], v[20:23], v[164:167]
    ds_read_b64_tr_b16 v[82:83], v106 offset:2304
    v_mfma_f32_16x16x32_bf16 v[140:143], v[36:39], v[20:23], v[140:143]
    ds_read_b64_tr_b16 v[84:85], v107 offset:2048
    v_mfma_f32_16x16x32_bf16 v[132:135], v[32:35], v[20:23], v[132:135]
    ds_read_b64_tr_b16 v[86:87], v107 offset:2304
    v_mfma_f32_16x16x32_bf16 v[144:147], v[32:35], v[24:27], v[144:147]
    ds_read_b64_tr_b16 v[88:89], v106 offset:6144
    v_mfma_f32_16x16x32_bf16 v[152:155], v[36:39], v[24:27], v[152:155]
    ds_read_b64_tr_b16 v[90:91], v106 offset:6400
    v_mfma_f32_16x16x32_bf16 v[176:179], v[40:43], v[24:27], v[176:179]
    ds_read_b64_tr_b16 v[2:3], v107 offset:6144
    v_mfma_f32_16x16x32_bf16 v[184:187], v[44:47], v[24:27], v[184:187]
    ds_read_b64_tr_b16 v[4:5], v107 offset:6400
    v_mfma_f32_16x16x32_bf16 v[188:191], v[44:47], v[28:31], v[188:191]
    ds_read_b64_tr_b16 v[6:7], v106 offset:10240
    v_mfma_f32_16x16x32_bf16 v[180:183], v[40:43], v[28:31], v[180:183]
    ds_read_b64_tr_b16 v[8:9], v106 offset:10496
    v_mfma_f32_16x16x32_bf16 v[156:159], v[36:39], v[28:31], v[156:159]
    ds_read_b64_tr_b16 v[96:97], v107 offset:10240
    v_mfma_f32_16x16x32_bf16 v[148:151], v[32:35], v[28:31], v[148:151]
    ds_read_b64_tr_b16 v[98:99], v107 offset:10496
    v_mfma_f32_16x16x32_bf16 v[220:223], v[28:31], v[52:55], v[220:223]
    v_mfma_f32_16x16x32_bf16 v[216:219], v[28:31], v[48:51], v[216:219]
    v_mfma_f32_16x16x32_bf16 v[208:211], v[24:27], v[48:51], v[208:211]
    v_mfma_f32_16x16x32_bf16 v[212:215], v[24:27], v[52:55], v[212:215]
    v_mfma_f32_16x16x32_bf16 v[204:207], v[20:23], v[52:55], v[204:207]
    v_mfma_f32_16x16x32_bf16 v[200:203], v[20:23], v[48:51], v[200:203]
    v_mfma_f32_16x16x32_bf16 v[192:195], v[16:19], v[48:51], v[192:195]
    v_mfma_f32_16x16x32_bf16 v[196:199], v[16:19], v[52:55], v[196:199]
    s_waitcnt vmcnt(0) lgkmcnt(0)
    s_barrier
    v_mfma_f32_16x16x32_bf16 v[128:131], v[80:83], v[64:67], v[128:131]
    s_mov_b32 s35, s29
    s_cmp_eq_u32 s29, 106496
    s_cselect_b32 s30, 4294860800, s86
    s_add_u32 s29, s29, s30
    v_add_u32 v104, s30, v104
    v_add_u32 v105, s30, v105
    v_add_u32 v106, s30, v106
    v_add_u32 v107, s30, v107
    v_mfma_f32_16x16x32_bf16 v[136:139], v[84:87], v[64:67], v[136:139]
    v_mfma_f32_16x16x32_bf16 v[160:163], v[88:91], v[64:67], v[160:163]
    ds_read_b128 v[16:19], v104 offset:0
    v_mfma_f32_16x16x32_bf16 v[168:171], v[2:5], v[64:67], v[168:171]
    ds_read_b128 v[20:23], v104 offset:2048
    v_mfma_f32_16x16x32_bf16 v[172:175], v[2:5], v[68:71], v[172:175]
    ds_read_b128 v[24:27], v104 offset:4096
    v_mfma_f32_16x16x32_bf16 v[164:167], v[88:91], v[68:71], v[164:167]
    ds_read_b128 v[28:31], v104 offset:6144
    v_mfma_f32_16x16x32_bf16 v[140:143], v[84:87], v[68:71], v[140:143]
    ds_read_b64_tr_b16 v[32:33], v106 offset:0
    v_mfma_f32_16x16x32_bf16 v[132:135], v[80:83], v[68:71], v[132:135]
    ds_read_b64_tr_b16 v[34:35], v106 offset:256
    v_mfma_f32_16x16x32_bf16 v[144:147], v[80:83], v[72:75], v[144:147]
    ds_read_b64_tr_b16 v[36:37], v107 offset:0
    v_mfma_f32_16x16x32_bf16 v[152:155], v[84:87], v[72:75], v[152:155]
    ds_read_b64_tr_b16 v[38:39], v107 offset:256
    v_mfma_f32_16x16x32_bf16 v[176:179], v[88:91], v[72:75], v[176:179]
    ds_read_b64_tr_b16 v[40:41], v106 offset:4096
    v_mfma_f32_16x16x32_bf16 v[184:187], v[2:5], v[72:75], v[184:187]
    ds_read_b64_tr_b16 v[42:43], v106 offset:4352
    v_mfma_f32_16x16x32_bf16 v[188:191], v[2:5], v[76:79], v[188:191]
    ds_read_b64_tr_b16 v[44:45], v107 offset:4096
    v_mfma_f32_16x16x32_bf16 v[180:183], v[88:91], v[76:79], v[180:183]
    ds_read_b64_tr_b16 v[46:47], v107 offset:4352
    v_mfma_f32_16x16x32_bf16 v[156:159], v[84:87], v[76:79], v[156:159]
    ds_read_b64_tr_b16 v[48:49], v106 offset:8192
    v_mfma_f32_16x16x32_bf16 v[148:151], v[80:83], v[76:79], v[148:151]
    ds_read_b64_tr_b16 v[50:51], v106 offset:8448
    v_mfma_f32_16x16x32_bf16 v[220:223], v[76:79], v[96:99], v[220:223]
    ds_read_b64_tr_b16 v[52:53], v107 offset:8192
    v_mfma_f32_16x16x32_bf16 v[216:219], v[76:79], v[6:9], v[216:219]
    ds_read_b64_tr_b16 v[54:55], v107 offset:8448
    v_mfma_f32_16x16x32_bf16 v[208:211], v[72:75], v[6:9], v[208:211]
    v_mfma_f32_16x16x32_bf16 v[212:215], v[72:75], v[96:99], v[212:215]
    v_mfma_f32_16x16x32_bf16 v[204:207], v[68:71], v[96:99], v[204:207]
    v_mfma_f32_16x16x32_bf16 v[200:203], v[68:71], v[6:9], v[200:203]
    v_mfma_f32_16x16x32_bf16 v[192:195], v[64:67], v[6:9], v[192:195]
    v_mfma_f32_16x16x32_bf16 v[196:199], v[64:67], v[96:99], v[196:199]
    s_add_u32 s28, s28, 2
    s_cmp_lg_u32 s3, 0
    s_cbranch_scc1 L_nn2
    v_mov_b32 v13, 0
    global_load_dwordx2 v[100:101], v13, s[72:73] sc1
L_nn2:
    s_waitcnt lgkmcnt(0)
    v_mfma_f32_16x16x32_bf16 v[128:131], v[32:35], v[16:19], v[128:131]
    ds_read_b128 v[64:67], v105 offset:0
    v_mfma_f32_16x16x32_bf16 v[136:139], v[36:39], v[16:19], v[136:139]
    ds_read_b128 v[68:71], v105 offset:2048
    v_mfma_f32_16x16x32_bf16 v[160:163], v[40:43], v[16:19], v[160:163]
    ds_read_b128 v[72:75], v105 offset:4096
    v_mfma_f32_16x16x32_bf16 v[168:171], v[44:47], v[16:19], v[168:171]
    ds_read_b128 v[76:79], v105 offset:6144
    v_mfma_f32_16x16x32_bf16 v[172:175], v[44:47], v[20:23], v[172:175]
    ds_read_b64_tr_b16 v[80:81], v106 offset:2048
    v_mfma_f32_16x16x32_bf16 v[164:167], v[40:43], v[20:23], v[164:167]
    ds_read_b64_tr_b16 v[82:83], v106 offset:2304
    v_mfma_f32_16x16x32_bf16 v[140:143], v[36:39], v[20:23], v[140:143]
    ds_read_b64_tr_b16 v[84:85], v107 offset:2048
    v_mfma_f32_16x16x32_bf16 v[132:135], v[32:35], v[20:23], v[132:135]
    ds_read_b64_tr_b16 v[86:87], v107 offset:2304
    v_mfma_f32_16x16x32_bf16 v[144:147], v[32:35], v[24:27], v[144:147]
    ds_read_b64_tr_b16 v[88:89], v106 offset:6144
    v_mfma_f32_16x16x32_bf16 v[152:155], v[36:39], v[24:27], v[152:155]
    ds_read_b64_tr_b16 v[90:91], v106 offset:6400
    v_mfma_f32_16x16x32_bf16 v[176:179], v[40:43], v[24:27], v[176:179]
    ds_read_b64_tr_b16 v[2:3], v107 offset:6144
    v_mfma_f32_16x16x32_bf16 v[184:187], v[44:47], v[24:27], v[184:187]
    ds_read_b64_tr_b16 v[4:5], v107 offset:6400
    v_mfma_f32_16x16x32_bf16 v[188:191], v[44:47], v[28:31], v[188:191]
    ds_read_b64_tr_b16 v[6:7], v106 offset:10240
    v_mfma_f32_16x16x32_bf16 v[180:183], v[40:43], v[28:31], v[180:183]
    ds_read_b64_tr_b16 v[8:9], v106 offset:10496
    v_mfma_f32_16x16x32_bf16 v[156:159], v[36:39], v[28:31], v[156:159]
    ds_read_b64_tr_b16 v[96:97], v107 offset:10240
    v_mfma_f32_16x16x32_bf16 v[148:151], v[32:35], v[28:31], v[148:151]
    ds_read_b64_tr_b16 v[98:99], v107 offset:10496
    v_mfma_f32_16x16x32_bf16 v[220:223], v[28:31], v[52:55], v[220:223]
    v_mfma_f32_16x16x32_bf16 v[216:219], v[28:31], v[48:51], v[216:219]
    v_mfma_f32_16x16x32_bf16 v[208:211], v[24:27], v[48:51], v[208:211]
    v_mfma_f32_16x16x32_bf16 v[212:215], v[24:27], v[52:55], v[212:215]
    v_mfma_f32_16x16x32_bf16 v[204:207], v[20:23], v[52:55], v[204:207]
    v_mfma_f32_16x16x32_bf16 v[200:203], v[20:23], v[48:51], v[200:203]
    v_mfma_f32_16x16x32_bf16 v[192:195], v[16:19], v[48:51], v[192:195]
    v_mfma_f32_16x16x32_bf16 v[196:199], v[16:19], v[52:55], v[196:199]
    s_waitcnt lgkmcnt(0)
    v_mfma_f32_16x16x32_bf16 v[128:131], v[80:83], v[64:67], v[128:131]
    v_mfma_f32_16x16x32_bf16 v[136:139], v[84:87], v[64:67], v[136:139]
    v_mfma_f32_16x16x32_bf16 v[160:163], v[88:91], v[64:67], v[160:163]
    v_mfma_f32_16x16x32_bf16 v[168:171], v[2:5], v[64:67], v[168:171]
    v_mfma_f32_16x16x32_bf16 v[172:175], v[2:5], v[68:71], v[172:175]
    v_mfma_f32_16x16x32_bf16 v[164:167], v[88:91], v[68:71], v[164:167]
    v_mfma_f32_16x16x32_bf16 v[140:143], v[84:87], v[68:71], v[140:143]
    v_mfma_f32_16x16x32_bf16 v[132:135], v[80:83], v[68:71], v[132:135]
    v_mfma_f32_16x16x32_bf16 v[144:147], v[80:83], v[72:75], v[144:147]
    v_mfma_f32_16x16x32_bf16 v[152:155], v[84:87], v[72:75], v[152:155]
    v_mfma_f32_16x16x32_bf16 v[176:179], v[88:91], v[72:75], v[176:179]
    v_mfma_f32_16x16x32_bf16 v[184:187], v[2:5], v[72:75], v[184:187]
    v_mfma_f32_16x16x32_bf16 v[188:191], v[2:5], v[76:79], v[188:191]
    v_mfma_f32_16x16x32_bf16 v[180:183], v[88:91], v[76:79], v[180:183]
    v_mfma_f32_16x16x32_bf16 v[156:159], v[84:87], v[76:79], v[156:159]
    v_mfma_f32_16x16x32_bf16 v[148:151], v[80:83], v[76:79], v[148:151]
    v_mfma_f32_16x16x32_bf16 v[220:223], v[76:79], v[96:99], v[220:223]
    v_mfma_f32_16x16x32_bf16 v[216:219], v[76:79], v[6:9], v[216:219]
    v_mfma_f32_16x16x32_bf16 v[208:211], v[72:75], v[6:9], v[208:211]
    v_mfma_f32_16x16x32_bf16 v[212:215], v[72:75], v[96:99], v[212:215]
    v_mfma_f32_16x16x32_bf16 v[204:207], v[68:71], v[96:99], v[204:207]
    v_mfma_f32_16x16x32_bf16 v[200:203], v[68:71], v[6:9], v[200:203]
    v_mfma_f32_16x16x32_bf16 v[192:195], v[64:67], v[6:9], v[192:195]
    v_mfma_f32_16x16x32_bf16 v[196:199], v[64:67], v[96:99], v[196:199]
    s_bitcmp1_b32 s83, 11
    s_cselect_b32 s12, s56, s54
    s_cselect_b32 s13, s57, s55
    s_mov_b32 s16, s66
    s_mov_b32 s17, s67
    s_mov_b32 s18, 0x200000
    s_nop 4
    s_waitcnt lgkmcnt(0)
    s_movk_i32 s36, 0x1000
    s_mov_b32 s34, 0x3e8293ee
    s_mov_b32 s35, s34
    v_cvt_pk_bf16_f32 v16, v160, v161
    v_cvt_pk_bf16_f32 v17, v162, v163
    v_cvt_pk_bf16_f32 v18, v164, v165
    v_cvt_pk_bf16_f32 v19, v166, v167
    v_cvt_pk_bf16_f32 v20, v168, v169
    v_cvt_pk_bf16_f32 v21, v170, v171
    v_cvt_pk_bf16_f32 v22, v172, v173
    v_cvt_pk_bf16_f32 v23, v174, v175
    v_permlane16_swap_b32 v16, v18
    v_permlane16_swap_b32 v17, v19
    buffer_store_dwordx4 v[16:19], v109, s[8:11], 0 offen offset:0 sc1
    ds_write_b128 v108, v[16:19] offset:0
    v_cvt_pk_bf16_f32 v24, v192, v193
    v_cvt_pk_bf16_f32 v25, v194, v195
    v_cvt_pk_bf16_f32 v26, v196, v197
    v_cvt_pk_bf16_f32 v27, v198, v199
    v_permlane16_swap_b32 v20, v22
    v_permlane16_swap_b32 v21, v23
    buffer_store_dwordx4 v[20:23], v109, s[8:11], 0 offen offset:1024 sc1
    ds_write_b128 v108, v[20:23] offset:1024
    v_cvt_pk_bf16_f32 v28, v200, v201
    v_cvt_pk_bf16_f32 v29, v202, v203
    v_cvt_pk_bf16_f32 v30, v204, v205
    v_cvt_pk_bf16_f32 v31, v206, v207
    v_permlane16_swap_b32 v24, v26
    v_permlane16_swap_b32 v25, v27
    buffer_store_dwordx4 v[24:27], v127, s[8:11], 0 offen offset:2048 sc1
    ds_write_b128 v103, v[24:27] offset:2048
    v_cvt_pk_bf16_f32 v32, v176, v177
    v_cvt_pk_bf16_f32 v33, v178, v179
    v_cvt_pk_bf16_f32 v34, v180, v181
    v_cvt_pk_bf16_f32 v35, v182, v183
    v_permlane16_swap_b32 v28, v30
    v_permlane16_swap_b32 v29, v31
    buffer_store_dwordx4 v[28:31], v127, s[8:11], 0 offen offset:3072 sc1
    ds_write_b128 v103, v[28:31] offset:3072
    v_cvt_pk_bf16_f32 v36, v184, v185
    v_cvt_pk_bf16_f32 v37, v186, v187
    v_cvt_pk_bf16_f32 v38, v188, v189
    v_cvt_pk_bf16_f32 v39, v190, v191
    v_permlane16_swap_b32 v32, v34
    v_permlane16_swap_b32 v33, v35
    buffer_store_dwordx4 v[32:35], v109, s[8:11], s36 offen offset:0 sc1
    ds_write_b128 v108, v[32:35] offset:4096
    v_cvt_pk_bf16_f32 v40, v208, v209
    v_cvt_pk_bf16_f32 v41, v210, v211
    v_cvt_pk_bf16_f32 v42, v212, v213
    v_cvt_pk_bf16_f32 v43, v214, v215
    v_permlane16_swap_b32 v36, v38
    v_permlane16_swap_b32 v37, v39
    buffer_store_dwordx4 v[36:39], v109, s[8:11], s36 offen offset:1024 sc1
    ds_write_b128 v108, v[36:39] offset:5120
    v_cvt_pk_bf16_f32 v44, v216, v217
    v_cvt_pk_bf16_f32 v45, v218, v219
    v_cvt_pk_bf16_f32 v46, v220, v221
    v_cvt_pk_bf16_f32 v47, v222, v223
    v_permlane16_swap_b32 v40, v42
    v_permlane16_swap_b32 v41, v43
    buffer_store_dwordx4 v[40:43], v127, s[8:11], s36 offen offset:2048 sc1
    ds_write_b128 v103, v[40:43] offset:6144
    v_pk_mul_f32 v[128:129], v[128:129], s[34:35]
    v_pk_mul_f32 v[130:131], v[130:131], s[34:35]
    v_pk_mul_f32 v[132:133], v[132:133], s[34:35]
    v_pk_mul_f32 v[134:135], v[134:135], s[34:35]
    v_permlane16_swap_b32 v44, v46
    v_permlane16_swap_b32 v45, v47
    buffer_store_dwordx4 v[44:47], v127, s[8:11], s36 offen offset:3072 sc1
    ds_write_b128 v103, v[44:47] offset:7168
    v_cvt_pk_bf16_f32 v48, v128, v129
    v_cvt_pk_bf16_f32 v49, v130, v131
    v_cvt_pk_bf16_f32 v50, v132, v133
    v_cvt_pk_bf16_f32 v51, v134, v135
    v_pk_mul_f32 v[136:137], v[136:137], s[34:35]
    v_pk_mul_f32 v[138:139], v[138:139], s[34:35]
    v_pk_mul_f32 v[140:141], v[140:141], s[34:35]
    v_pk_mul_f32 v[142:143], v[142:143], s[34:35]
    v_permlane16_swap_b32 v48, v50
    v_permlane16_swap_b32 v49, v51
    ds_write_b128 v102, v[48:51] offset:0
    v_cvt_pk_bf16_f32 v52, v136, v137
    v_cvt_pk_bf16_f32 v53, v138, v139
    v_cvt_pk_bf16_f32 v54, v140, v141
    v_cvt_pk_bf16_f32 v55, v142, v143
    v_pk_mul_f32 v[144:145], v[144:145], s[34:35]
    v_pk_mul_f32 v[146:147], v[146:147], s[34:35]
    v_pk_mul_f32 v[148:149], v[148:149], s[34:35]
    v_pk_mul_f32 v[150:151], v[150:151], s[34:35]
    v_permlane16_swap_b32 v52, v54
    v_permlane16_swap_b32 v53, v55
    ds_write_b128 v102, v[52:55] offset:1024
    v_cvt_pk_bf16_f32 v56, v144, v145
    v_cvt_pk_bf16_f32 v57, v146, v147
    v_cvt_pk_bf16_f32 v58, v148, v149
    v_cvt_pk_bf16_f32 v59, v150, v151
    v_pk_mul_f32 v[152:153], v[152:153], s[34:35]
    v_pk_mul_f32 v[154:155], v[154:155], s[34:35]
    v_pk_mul_f32 v[156:157], v[156:157], s[34:35]
    v_pk_mul_f32 v[158:159], v[158:159], s[34:35]
    v_permlane16_swap_b32 v56, v58
    v_permlane16_swap_b32 v57, v59
    ds_write_b128 v102, v[56:59] offset:128
    v_cvt_pk_bf16_f32 v60, v152, v153
    v_cvt_pk_bf16_f32 v61, v154, v155
    v_cvt_pk_bf16_f32 v62, v156, v157
    v_cvt_pk_bf16_f32 v63, v158, v159
    s_nop 0
    v_permlane16_swap_b32 v60, v62
    v_permlane16_swap_b32 v61, v63
    ds_write_b128 v102, v[60:63] offset:1152
    s_cmp_lg_u32 s3, 0
    s_cbranch_scc1 L_q1
    s_mov_b32 s34, 0
    s_waitcnt vmcnt(8)
L_nl:
    v_readfirstlane_b32 s40, v100
    v_readfirstlane_b32 s41, v101
    s_add_u32 s34, s34, 1
    s_cmp_lg_u64 s[40:41], 0
    s_cbranch_scc1 L_nd
    s_cmp_ge_u32 s34, 0x40000
    s_cbranch_scc1 L_nd
    s_sleep 2
    global_load_dwordx2 v[100:101], v13, s[72:73] sc1
    s_waitcnt vmcnt(0)
    s_branch L_nl
L_nd:
    v_mov_b32 v4, s40
    v_mov_b32 v5, s41
    v_mov_b32 v3, 116736
    ds_write_b64 v3, v[4:5]
L_q1:
    s_waitcnt lgkmcnt(0)
    s_barrier
    s_branch L_att
L_g1U:
    v_lshlrev_b32 v2, 3, v1
    s_lshl_b32 s34, s37, 9
    s_add_u32 s34, s34, 114688
    v_add_u32 v102, s34, v2
    v_and_b32 v127, 0xff, v2
    v_add_u32 v103, 114688, v127
    v_lshlrev_b32 v127, 1, v127
    v_mov_b32 v101, 116736
    s_setprio 1
    v_and_b32 v9, 0x33, v1
    v_bfe_u32 v7, v1, 2, 1
    v_lshl_add_u32 v9, v7, 3, v9
    v_bfe_u32 v7, v1, 3, 1
    v_lshl_add_u32 v9, v7, 2, v9
    v_lshrrev_b32 v8, 4, v1
    v_bfe_u32 v7, v9, 1, 3
    v_xor_b32 v7, v7, v8
    v_lshlrev_b32 v7, 4, v7
    v_and_b32 v6, 15, v9
    v_lshl_add_u32 v7, v6, 7, v7
    s_lshl_b32 s34, s37, 13
    v_add_u32 v104, s34, v7
    v_xor_b32 v105, 64, v104
    v_bfe_u32 v7, v1, 1, 3
    v_xor_b32 v7, v7, v8
    v_lshlrev_b32 v7, 4, v7
    v_and_b32 v6, 15, v1
    v_lshl_add_u32 v106, v6, 7, v7
    v_xor_b32 v107, 64, v106
    buffer_load_dwordx4 v62, s[4:7], s31 offen offset:2048 lds
    buffer_load_dwordx4 v63, s[4:7], s31 offen offset:3072 lds
    global_load_ushort v224, v227, s[46:47]
    global_load_ushort v225, v227, s[48:49]
    global_load_ushort v226, v227, s[58:59]
    s_lshl_b32 s31, s33, 7
    s_mul_i32 s32, s33, 393216
    s_add_u32 s33, s33, 1
    s_and_b32 s33, s33, 15
    s_add_u32 m0, s86, s38
    s_nop 0
    buffer_load_dwordx4 v56, s[4:7], s31 offen offset:0 lds
    buffer_load_dwordx4 v57, s[4:7], s31 offen offset:1024 lds
    buffer_load_dwordx4 v58, s[4:7], s31 offen offset:2048 lds
    buffer_load_dwordx4 v59, s[4:7], s31 offen offset:3072 lds
    s_add_u32 m0, m0, 4096
    s_nop 0
    buffer_load_dwordx4 v60, s[4:7], s31 offen offset:0 lds
    buffer_load_dwordx4 v61, s[4:7], s31 offen offset:1024 lds
    buffer_load_dwordx4 v62, s[4:7], s31 offen offset:2048 lds
    buffer_load_dwordx4 v63, s[4:7], s31 offen offset:3072 lds
    s_waitcnt vmcnt(8)
    s_barrier
    ds_read_b128 v[16:19], v104 offset:0
    ds_read_b128 v[32:35], v106 offset:32768
    ds_read_b128 v[20:23], v104 offset:2048
    ds_read_b128 v[36:39], v106 offset:34816
    ds_read_b128 v[24:27], v104 offset:4096
    ds_read_b128 v[40:43], v106 offset:36864
    ds_read_b128 v[28:31], v104 offset:6144
    ds_read_b128 v[44:47], v106 offset:38912
    s_mov_b32 s35, 106496
    s_lshl_b32 s31, s33, 7
    s_mul_i32 s32, s33, 393216
    s_add_u32 s33, s33, 1
    s_and_b32 s33, s33, 15
    s_add_u32 m0, s35, s38
    s_nop 0
    buffer_load_dwordx4 v56, s[4:7], s31 offen offset:0 lds
    buffer_load_dwordx4 v57, s[4:7], s31 offen offset:1024 lds
    buffer_load_dwordx4 v58, s[4:7], s31 offen offset:2048 lds
    buffer_load_dwordx4 v59, s[4:7], s31 offen offset:3072 lds
    v_lshlrev_b32 v224, 16, v224
    v_lshlrev_b32 v225, 16, v225
    v_lshlrev_b32 v226, 16, v226
    v_mul_f32 v226, 0x3fb8aa3b, v226
    v_exp_f32 v226, v226
    s_nop 0
    v_cvt_pk_bf16_f32 v226, v226, v226
    v_and_b32 v226, 0xffff0000, v226
    v_mul_f32 v227, v226, v224
    v_mul_f32 v226, v226, v225
    v_mul_f32 v227, 0x3fb8aa3b, v227
    v_exp_f32 v227, v227
    v_mul_f32 v226, 0x3e22f983, v226
    v_rndne_f32 v242, v226
    v_sub_f32 v226, v226, v242
    v_cos_f32 v228, v226
    v_sin_f32 v229, v226
    v_mul_f32 v228, v227, v228
    v_mul_f32 v229, v227, v229
    v_mul_f32 v242, v224, v224
    v_fma_f32 v242, v225, v225, v242
    v_rcp_f32 v242, v242
    v_add_f32 v243, -1.0, v228
    v_add_f32 v242, v242, v242
    v_mul_f32 v230, v243, v224
    v_fma_f32 v230, v229, v225, v230
    v_mul_f32 v231, v243, v225
    v_fma_f32 v231, v229, v224, -v231
    v_mul_f32 v230, v230, v242
    v_mul_f32 v231, v231, v242
    v_pk_mul_f32 v[242:243], v[228:229], v[228:229] op_sel_hi:[0,1]
    v_pk_fma_f32 v[232:233], v[228:229], v[228:229], v[242:243] op_sel:[1,1,0] op_sel_hi:[1,0,1] neg_lo:[1,0,0]
    v_pk_mul_f32 v[242:243], v[232:233], v[232:233] op_sel_hi:[0,1]
    v_pk_fma_f32 v[232:233], v[232:233], v[232:233], v[242:243] op_sel:[1,1,0] op_sel_hi:[1,0,1] neg_lo:[1,0,0]
    v_pk_mul_f32 v[242:243], v[232:233], v[232:233] op_sel_hi:[0,1]
    v_pk_fma_f32 v[232:233], v[232:233], v[232:233], v[242:243] op_sel:[1,1,0] op_sel_hi:[1,0,1] neg_lo:[1,0,0]
    v_pk_mul_f32 v[242:243], v[232:233], v[232:233] op_sel_hi:[0,1]
    v_pk_fma_f32 v[232:233], v[232:233], v[232:233], v[242:243] op_sel:[1,1,0] op_sel_hi:[1,0,1] neg_lo:[1,0,0]
    v_pk_mul_f32 v[242:243], v[232:233], v[232:233] op_sel_hi:[0,1]
    v_pk_fma_f32 v[234:235], v[232:233], v[232:233], v[242:243] op_sel:[1,1,0] op_sel_hi:[1,0,1] neg_lo:[1,0,0]
    v_pk_mul_f32 v[242:243], v[234:235], v[234:235] op_sel_hi:[0,1]
    v_pk_fma_f32 v[244:245], v[234:235], v[234:235], v[242:243] op_sel:[1,1,0] op_sel_hi:[1,0,1] neg_lo:[1,0,0]
    v_pk_mul_f32 v[242:243], v[244:245], v[244:245] op_sel_hi:[0,1]
    v_pk_fma_f32 v[246:247], v[244:245], v[244:245], v[242:243] op_sel:[1,1,0] op_sel_hi:[1,0,1] neg_lo:[1,0,0]
    v_pk_mul_f32 v[242:243], v[246:247], v[246:247] op_sel_hi:[0,1]
    v_pk_fma_f32 v[236:237], v[246:247], v[246:247], v[242:243] op_sel:[1,1,0] op_sel_hi:[1,0,1] neg_lo:[1,0,0]
    v_cmp_lt_u32 vcc, 31, v1
    s_nop 1
    v_cndmask_b32 v238, 1.0, v234, vcc
    v_cndmask_b32 v239, 0, v235, vcc
    s_bitcmp0_b32 s37, 0
    s_cbranch_scc1 L_l1
    v_pk_mul_f32 v[242:243], v[244:245], v[238:239] op_sel_hi:[0,1]
    v_pk_fma_f32 v[238:239], v[244:245], v[238:239], v[242:243] op_sel:[1,1,0] op_sel_hi:[1,0,1] neg_lo:[1,0,0]
L_l1:
    s_bitcmp0_b32 s37, 1
    s_cbranch_scc1 L_lm2
    v_pk_mul_f32 v[242:243], v[246:247], v[238:239] op_sel_hi:[0,1]
    v_pk_fma_f32 v[238:239], v[246:247], v[238:239], v[242:243] op_sel:[1,1,0] op_sel_hi:[1,0,1] neg_lo:[1,0,0]
L_lm2:
L_g1U_loop:
    s_waitcnt lgkmcnt(0)
    v_mfma_f32_16x16x32_bf16 v[128:131], v[16:19], v[32:35], v[128:131]
    ds_read_b128 v[64:67], v105 offset:0
    v_mfma_f32_16x16x32_bf16 v[132:135], v[16:19], v[36:39], v[132:135]
    ds_read_b128 v[80:83], v107 offset:32768
    v_mfma_f32_16x16x32_bf16 v[160:163], v[16:19], v[40:43], v[160:163]
    ds_read_b128 v[68:71], v105 offset:2048
    v_mfma_f32_16x16x32_bf16 v[164:167], v[16:19], v[44:47], v[164:167]
    ds_read_b128 v[84:87], v107 offset:34816
    v_mfma_f32_16x16x32_bf16 v[172:175], v[20:23], v[44:47], v[172:175]
    ds_read_b128 v[72:75], v105 offset:4096
    v_mfma_f32_16x16x32_bf16 v[168:171], v[20:23], v[40:43], v[168:171]
    ds_read_b128 v[88:91], v107 offset:36864
    v_mfma_f32_16x16x32_bf16 v[140:143], v[20:23], v[36:39], v[140:143]
    ds_read_b128 v[76:79], v105 offset:6144
    v_mfma_f32_16x16x32_bf16 v[136:139], v[20:23], v[32:35], v[136:139]
    ds_read_b128 v[48:51], v107 offset:38912
    v_mfma_f32_16x16x32_bf16 v[144:147], v[24:27], v[32:35], v[144:147]
    s_add_u32 m0, m0, 4096
    s_nop 0
    buffer_load_dwordx4 v60, s[4:7], s31 offen offset:0 lds
    v_mfma_f32_16x16x32_bf16 v[148:151], v[24:27], v[36:39], v[148:151]
    v_mfma_f32_16x16x32_bf16 v[176:179], v[24:27], v[40:43], v[176:179]
    buffer_load_dwordx4 v61, s[4:7], s31 offen offset:1024 lds
    v_mfma_f32_16x16x32_bf16 v[180:183], v[24:27], v[44:47], v[180:183]
    v_mfma_f32_16x16x32_bf16 v[188:191], v[28:31], v[44:47], v[188:191]
    buffer_load_dwordx4 v62, s[4:7], s31 offen offset:2048 lds
    v_mfma_f32_16x16x32_bf16 v[184:187], v[28:31], v[40:43], v[184:187]
    v_mfma_f32_16x16x32_bf16 v[156:159], v[28:31], v[36:39], v[156:159]
    buffer_load_dwordx4 v63, s[4:7], s31 offen offset:3072 lds
    v_mfma_f32_16x16x32_bf16 v[152:155], v[28:31], v[32:35], v[152:155]
    s_cmp_ge_u32 s28, 13
    s_cbranch_scc1 L_g1U_tail
    s_waitcnt vmcnt(8) lgkmcnt(0)
    s_barrier
    v_mfma_f32_16x16x32_bf16 v[128:131], v[64:67], v[80:83], v[128:131]
    s_mov_b32 s35, s29
    s_cmp_eq_u32 s29, 106496
    s_cselect_b32 s30, 4294860800, s86
    s_add_u32 s29, s29, s30
    v_add_u32 v104, s30, v104
    v_add_u32 v105, s30, v105
    v_add_u32 v106, s30, v106
    v_add_u32 v107, s30, v107
    v_mfma_f32_16x16x32_bf16 v[132:135], v[64:67], v[84:87], v[132:135]
    s_lshl_b32 s31, s33, 7
    s_mul_i32 s32, s33, 393216
    s_add_u32 s33, s33, 1
    s_and_b32 s33, s33, 15
    v_mfma_f32_16x16x32_bf16 v[160:163], v[64:67], v[88:91], v[160:163]
    ds_read_b128 v[16:19], v104 offset:0
    v_mfma_f32_16x16x32_bf16 v[164:167], v[64:67], v[48:51], v[164:167]
    ds_read_b128 v[32:35], v106 offset:32768
    v_mfma_f32_16x16x32_bf16 v[172:175], v[68:71], v[48:51], v[172:175]
    ds_read_b128 v[20:23], v104 offset:2048
    v_mfma_f32_16x16x32_bf16 v[168:171], v[68:71], v[88:91], v[168:171]
    ds_read_b128 v[36:39], v106 offset:34816
    v_mfma_f32_16x16x32_bf16 v[140:143], v[68:71], v[84:87], v[140:143]
    ds_read_b128 v[24:27], v104 offset:4096
    v_mfma_f32_16x16x32_bf16 v[136:139], v[68:71], v[80:83], v[136:139]
    ds_read_b128 v[40:43], v106 offset:36864
    v_mfma_f32_16x16x32_bf16 v[144:147], v[72:75], v[80:83], v[144:147]
    ds_read_b128 v[28:31], v104 offset:6144
    v_mfma_f32_16x16x32_bf16 v[148:151], v[72:75], v[84:87], v[148:151]
    ds_read_b128 v[44:47], v106 offset:38912
    v_mfma_f32_16x16x32_bf16 v[176:179], v[72:75], v[88:91], v[176:179]
    s_add_u32 m0, s35, s38
    s_nop 0
    buffer_load_dwordx4 v56, s[4:7], s31 offen offset:0 lds
    v_mfma_f32_16x16x32_bf16 v[180:183], v[72:75], v[48:51], v[180:183]
    buffer_load_dwordx4 v57, s[4:7], s31 offen offset:1024 lds
    v_mfma_f32_16x16x32_bf16 v[188:191], v[76:79], v[48:51], v[188:191]
    buffer_load_dwordx4 v58, s[4:7], s31 offen offset:2048 lds
    v_mfma_f32_16x16x32_bf16 v[184:187], v[76:79], v[88:91], v[184:187]
    buffer_load_dwordx4 v59, s[4:7], s31 offen offset:3072 lds
    v_mfma_f32_16x16x32_bf16 v[156:159], v[76:79], v[84:87], v[156:159]
    v_mfma_f32_16x16x32_bf16 v[152:155], v[76:79], v[80:83], v[152:155]
    s_add_u32 s28, s28, 1
    s_branch L_g1U_loop
L_g1U_tail:
    s_waitcnt vmcnt(8) lgkmcnt(0)
    s_barrier
    v_mfma_f32_16x16x32_bf16 v[128:131], v[64:67], v[80:83], v[128:131]
    s_mov_b32 s35, s29
    s_cmp_eq_u32 s29, 106496
    s_cselect_b32 s30, 4294860800, s86
    s_add_u32 s29, s29, s30
    v_add_u32 v104, s30, v104
    v_add_u32 v105, s30, v105
    v_add_u32 v106, s30, v106
    v_add_u32 v107, s30, v107
    v_mfma_f32_16x16x32_bf16 v[132:135], v[64:67], v[84:87], v[132:135]
    v_mfma_f32_16x16x32_bf16 v[160:163], v[64:67], v[88:91], v[160:163]
    ds_read_b128 v[16:19], v104 offset:0
    v_mfma_f32_16x16x32_bf16 v[164:167], v[64:67], v[48:51], v[164:167]
    ds_read_b128 v[32:35], v106 offset:32768
    v_mfma_f32_16x16x32_bf16 v[172:175], v[68:71], v[48:51], v[172:175]
    ds_read_b128 v[20:23], v104 offset:2048
    v_mfma_f32_16x16x32_bf16 v[168:171], v[68:71], v[88:91], v[168:171]
    ds_read_b128 v[36:39], v106 offset:34816
    v_mfma_f32_16x16x32_bf16 v[140:143], v[68:71], v[84:87], v[140:143]
    ds_read_b128 v[24:27], v104 offset:4096
    v_mfma_f32_16x16x32_bf16 v[136:139], v[68:71], v[80:83], v[136:139]
    ds_read_b128 v[40:43], v106 offset:36864
    v_mfma_f32_16x16x32_bf16 v[144:147], v[72:75], v[80:83], v[144:147]
    ds_read_b128 v[28:31], v104 offset:6144
    v_mfma_f32_16x16x32_bf16 v[148:151], v[72:75], v[84:87], v[148:151]
    ds_read_b128 v[44:47], v106 offset:38912
    v_mfma_f32_16x16x32_bf16 v[176:179], v[72:75], v[88:91], v[176:179]
    v_mfma_f32_16x16x32_bf16 v[180:183], v[72:75], v[48:51], v[180:183]
    v_mfma_f32_16x16x32_bf16 v[188:191], v[76:79], v[48:51], v[188:191]
    v_mfma_f32_16x16x32_bf16 v[184:187], v[76:79], v[88:91], v[184:187]
    v_mfma_f32_16x16x32_bf16 v[156:159], v[76:79], v[84:87], v[156:159]
    v_mfma_f32_16x16x32_bf16 v[152:155], v[76:79], v[80:83], v[152:155]
    s_waitcnt lgkmcnt(0)
    v_mfma_f32_16x16x32_bf16 v[128:131], v[16:19], v[32:35], v[128:131]
    ds_read_b128 v[64:67], v105 offset:0
    v_mfma_f32_16x16x32_bf16 v[132:135], v[16:19], v[36:39], v[132:135]
    ds_read_b128 v[80:83], v107 offset:32768
    v_mfma_f32_16x16x32_bf16 v[160:163], v[16:19], v[40:43], v[160:163]
    ds_read_b128 v[68:71], v105 offset:2048
    v_mfma_f32_16x16x32_bf16 v[164:167], v[16:19], v[44:47], v[164:167]
    ds_read_b128 v[84:87], v107 offset:34816
    v_mfma_f32_16x16x32_bf16 v[172:175], v[20:23], v[44:47], v[172:175]
    ds_read_b128 v[72:75], v105 offset:4096
    v_mfma_f32_16x16x32_bf16 v[168:171], v[20:23], v[40:43], v[168:171]
    ds_read_b128 v[88:91], v107 offset:36864
    v_mfma_f32_16x16x32_bf16 v[140:143], v[20:23], v[36:39], v[140:143]
    ds_read_b128 v[76:79], v105 offset:6144
    v_mfma_f32_16x16x32_bf16 v[136:139], v[20:23], v[32:35], v[136:139]
    ds_read_b128 v[48:51], v107 offset:38912
    v_mfma_f32_16x16x32_bf16 v[144:147], v[24:27], v[32:35], v[144:147]
    v_mfma_f32_16x16x32_bf16 v[148:151], v[24:27], v[36:39], v[148:151]
    v_mfma_f32_16x16x32_bf16 v[176:179], v[24:27], v[40:43], v[176:179]
    v_mfma_f32_16x16x32_bf16 v[180:183], v[24:27], v[44:47], v[180:183]
    v_mfma_f32_16x16x32_bf16 v[188:191], v[28:31], v[44:47], v[188:191]
    v_mfma_f32_16x16x32_bf16 v[184:187], v[28:31], v[40:43], v[184:187]
    v_mfma_f32_16x16x32_bf16 v[156:159], v[28:31], v[36:39], v[156:159]
    v_mfma_f32_16x16x32_bf16 v[152:155], v[28:31], v[32:35], v[152:155]
    s_waitcnt vmcnt(0) lgkmcnt(0)
    s_barrier
    v_mfma_f32_16x16x32_bf16 v[128:131], v[64:67], v[80:83], v[128:131]
    s_mov_b32 s35, s29
    s_cmp_eq_u32 s29, 106496
    s_cselect_b32 s30, 4294860800, s86
    s_add_u32 s29, s29, s30
    v_add_u32 v104, s30, v104
    v_add_u32 v105, s30, v105
    v_add_u32 v106, s30, v106
    v_add_u32 v107, s30, v107
    v_mfma_f32_16x16x32_bf16 v[132:135], v[64:67], v[84:87], v[132:135]
    v_mfma_f32_16x16x32_bf16 v[160:163], v[64:67], v[88:91], v[160:163]
    ds_read_b128 v[16:19], v104 offset:0
    v_mfma_f32_16x16x32_bf16 v[164:167], v[64:67], v[48:51], v[164:167]
    ds_read_b128 v[32:35], v106 offset:32768
    v_mfma_f32_16x16x32_bf16 v[172:175], v[68:71], v[48:51], v[172:175]
    ds_read_b128 v[20:23], v104 offset:2048
    v_mfma_f32_16x16x32_bf16 v[168:171], v[68:71], v[88:91], v[168:171]
    ds_read_b128 v[36:39], v106 offset:34816
    v_mfma_f32_16x16x32_bf16 v[140:143], v[68:71], v[84:87], v[140:143]
    ds_read_b128 v[24:27], v104 offset:4096
    v_mfma_f32_16x16x32_bf16 v[136:139], v[68:71], v[80:83], v[136:139]
    ds_read_b128 v[40:43], v106 offset:36864
    v_mfma_f32_16x16x32_bf16 v[144:147], v[72:75], v[80:83], v[144:147]
    ds_read_b128 v[28:31], v104 offset:6144
    v_mfma_f32_16x16x32_bf16 v[148:151], v[72:75], v[84:87], v[148:151]
    ds_read_b128 v[44:47], v106 offset:38912
    v_mfma_f32_16x16x32_bf16 v[176:179], v[72:75], v[88:91], v[176:179]
    v_mfma_f32_16x16x32_bf16 v[180:183], v[72:75], v[48:51], v[180:183]
    v_mfma_f32_16x16x32_bf16 v[188:191], v[76:79], v[48:51], v[188:191]
    v_mfma_f32_16x16x32_bf16 v[184:187], v[76:79], v[88:91], v[184:187]
    v_mfma_f32_16x16x32_bf16 v[156:159], v[76:79], v[84:87], v[156:159]
    v_mfma_f32_16x16x32_bf16 v[152:155], v[76:79], v[80:83], v[152:155]
    s_add_u32 s28, s28, 2
    s_waitcnt lgkmcnt(0)
    v_mfma_f32_16x16x32_bf16 v[128:131], v[16:19], v[32:35], v[128:131]
    ds_read_b128 v[64:67], v105 offset:0
    v_mfma_f32_16x16x32_bf16 v[132:135], v[16:19], v[36:39], v[132:135]
    ds_read_b128 v[80:83], v107 offset:32768
    v_mfma_f32_16x16x32_bf16 v[160:163], v[16:19], v[40:43], v[160:163]
    ds_read_b128 v[68:71], v105 offset:2048
    v_mfma_f32_16x16x32_bf16 v[164:167], v[16:19], v[44:47], v[164:167]
    ds_read_b128 v[84:87], v107 offset:34816
    v_mfma_f32_16x16x32_bf16 v[172:175], v[20:23], v[44:47], v[172:175]
    ds_read_b128 v[72:75], v105 offset:4096
    v_mfma_f32_16x16x32_bf16 v[168:171], v[20:23], v[40:43], v[168:171]
    ds_read_b128 v[88:91], v107 offset:36864
    v_mfma_f32_16x16x32_bf16 v[140:143], v[20:23], v[36:39], v[140:143]
    ds_read_b128 v[76:79], v105 offset:6144
    v_mfma_f32_16x16x32_bf16 v[136:139], v[20:23], v[32:35], v[136:139]
    ds_read_b128 v[48:51], v107 offset:38912
    v_mfma_f32_16x16x32_bf16 v[144:147], v[24:27], v[32:35], v[144:147]
    v_mfma_f32_16x16x32_bf16 v[148:151], v[24:27], v[36:39], v[148:151]
    v_mfma_f32_16x16x32_bf16 v[176:179], v[24:27], v[40:43], v[176:179]
    v_mfma_f32_16x16x32_bf16 v[180:183], v[24:27], v[44:47], v[180:183]
    v_mfma_f32_16x16x32_bf16 v[188:191], v[28:31], v[44:47], v[188:191]
    v_mfma_f32_16x16x32_bf16 v[184:187], v[28:31], v[40:43], v[184:187]
    v_mfma_f32_16x16x32_bf16 v[156:159], v[28:31], v[36:39], v[156:159]
    v_mfma_f32_16x16x32_bf16 v[152:155], v[28:31], v[32:35], v[152:155]
    s_waitcnt lgkmcnt(0)
    v_mfma_f32_16x16x32_bf16 v[128:131], v[64:67], v[80:83], v[128:131]
    v_mfma_f32_16x16x32_bf16 v[132:135], v[64:67], v[84:87], v[132:135]
    v_mfma_f32_16x16x32_bf16 v[160:163], v[64:67], v[88:91], v[160:163]
    v_mfma_f32_16x16x32_bf16 v[164:167], v[64:67], v[48:51], v[164:167]
    v_mfma_f32_16x16x32_bf16 v[172:175], v[68:71], v[48:51], v[172:175]
    v_mfma_f32_16x16x32_bf16 v[168:171], v[68:71], v[88:91], v[168:171]
    v_mfma_f32_16x16x32_bf16 v[140:143], v[68:71], v[84:87], v[140:143]
    v_mfma_f32_16x16x32_bf16 v[136:139], v[68:71], v[80:83], v[136:139]
    v_mfma_f32_16x16x32_bf16 v[144:147], v[72:75], v[80:83], v[144:147]
    v_mfma_f32_16x16x32_bf16 v[148:151], v[72:75], v[84:87], v[148:151]
    v_mfma_f32_16x16x32_bf16 v[176:179], v[72:75], v[88:91], v[176:179]
    v_mfma_f32_16x16x32_bf16 v[180:183], v[72:75], v[48:51], v[180:183]
    v_mfma_f32_16x16x32_bf16 v[188:191], v[76:79], v[48:51], v[188:191]
    v_mfma_f32_16x16x32_bf16 v[184:187], v[76:79], v[88:91], v[184:187]
    v_mfma_f32_16x16x32_bf16 v[156:159], v[76:79], v[84:87], v[156:159]
    v_mfma_f32_16x16x32_bf16 v[152:155], v[76:79], v[80:83], v[152:155]
    s_bitcmp1_b32 s83, 11
    s_cselect_b32 s12, s56, s54
    s_cselect_b32 s13, s57, s55
    s_mov_b32 s16, s66
    s_mov_b32 s17, s67
    s_mov_b32 s18, 0x200000
    s_nop 4
    v_permlane16_swap_b32 v128, v132
    v_permlane16_swap_b32 v129, v133
    v_permlane16_swap_b32 v130, v134
    v_permlane16_swap_b32 v131, v135
    v_permlane16_swap_b32 v160, v164
    v_permlane16_swap_b32 v161, v165
    v_permlane16_swap_b32 v162, v166
    v_permlane16_swap_b32 v163, v167
    v_permlane16_swap_b32 v136, v140
    v_permlane16_swap_b32 v137, v141
    v_permlane16_swap_b32 v138, v142
    v_permlane16_swap_b32 v139, v143
    v_permlane16_swap_b32 v168, v172
    v_permlane16_swap_b32 v169, v173
    v_permlane16_swap_b32 v170, v174
    v_permlane16_swap_b32 v171, v175
    v_permlane16_swap_b32 v144, v148
    v_permlane16_swap_b32 v145, v149
    v_permlane16_swap_b32 v146, v150
    v_permlane16_swap_b32 v147, v151
    v_permlane16_swap_b32 v176, v180
    v_permlane16_swap_b32 v177, v181
    v_permlane16_swap_b32 v178, v182
    v_permlane16_swap_b32 v179, v183
    v_permlane16_swap_b32 v152, v156
    v_permlane16_swap_b32 v153, v157
    v_permlane16_swap_b32 v154, v158
    v_permlane16_swap_b32 v155, v159
    v_permlane16_swap_b32 v184, v188
    v_permlane16_swap_b32 v185, v189
    v_permlane16_swap_b32 v186, v190
    v_permlane16_swap_b32 v187, v191
    s_waitcnt lgkmcnt(0)
    v_pk_fma_f32 v[24:25], v[228:229], v[128:129], v[130:131] op_sel_hi:[0,1,1]
    v_pk_fma_f32 v[26:27], v[228:229], v[160:161], v[162:163] op_sel_hi:[0,1,1]
    v_pk_fma_f32 v[16:17], v[228:229], v[160:161], v[24:25] op_sel:[1,0,0] neg_lo:[1,0,0] neg_hi:[1,0,0]
    v_pk_fma_f32 v[18:19], v[228:229], v[128:129], v[26:27] op_sel:[1,0,0]
    v_pk_fma_f32 v[24:25], v[228:229], v[16:17], v[132:133] op_sel_hi:[0,1,1]
    v_pk_fma_f32 v[26:27], v[228:229], v[18:19], v[164:165] op_sel_hi:[0,1,1]
    v_pk_fma_f32 v[20:21], v[228:229], v[18:19], v[24:25] op_sel:[1,0,0] neg_lo:[1,0,0] neg_hi:[1,0,0]
    v_pk_fma_f32 v[22:23], v[228:229], v[16:17], v[26:27] op_sel:[1,0,0]
    v_pk_fma_f32 v[24:25], v[228:229], v[20:21], v[134:135] op_sel_hi:[0,1,1]
    v_pk_fma_f32 v[26:27], v[228:229], v[22:23], v[166:167] op_sel_hi:[0,1,1]
    v_pk_fma_f32 v[16:17], v[228:229], v[22:23], v[24:25] op_sel:[1,0,0] neg_lo:[1,0,0] neg_hi:[1,0,0]
    v_pk_fma_f32 v[18:19], v[228:229], v[20:21], v[26:27] op_sel:[1,0,0]
    v_pk_fma_f32 v[24:25], v[228:229], v[16:17], v[136:137] op_sel_hi:[0,1,1]
    v_pk_fma_f32 v[26:27], v[228:229], v[18:19], v[168:169] op_sel_hi:[0,1,1]
    v_pk_fma_f32 v[20:21], v[228:229], v[18:19], v[24:25] op_sel:[1,0,0] neg_lo:[1,0,0] neg_hi:[1,0,0]
    v_pk_fma_f32 v[22:23], v[228:229], v[16:17], v[26:27] op_sel:[1,0,0]
    v_pk_fma_f32 v[24:25], v[228:229], v[20:21], v[138:139] op_sel_hi:[0,1,1]
    v_pk_fma_f32 v[26:27], v[228:229], v[22:23], v[170:171] op_sel_hi:[0,1,1]
    v_pk_fma_f32 v[16:17], v[228:229], v[22:23], v[24:25] op_sel:[1,0,0] neg_lo:[1,0,0] neg_hi:[1,0,0]
    v_pk_fma_f32 v[18:19], v[228:229], v[20:21], v[26:27] op_sel:[1,0,0]
    v_pk_fma_f32 v[24:25], v[228:229], v[16:17], v[140:141] op_sel_hi:[0,1,1]
    v_pk_fma_f32 v[26:27], v[228:229], v[18:19], v[172:173] op_sel_hi:[0,1,1]
    v_pk_fma_f32 v[20:21], v[228:229], v[18:19], v[24:25] op_sel:[1,0,0] neg_lo:[1,0,0] neg_hi:[1,0,0]
    v_pk_fma_f32 v[22:23], v[228:229], v[16:17], v[26:27] op_sel:[1,0,0]
    v_pk_fma_f32 v[24:25], v[228:229], v[20:21], v[142:143] op_sel_hi:[0,1,1]
    v_pk_fma_f32 v[26:27], v[228:229], v[22:23], v[174:175] op_sel_hi:[0,1,1]
    v_pk_fma_f32 v[16:17], v[228:229], v[22:23], v[24:25] op_sel:[1,0,0] neg_lo:[1,0,0] neg_hi:[1,0,0]
    v_pk_fma_f32 v[18:19], v[228:229], v[20:21], v[26:27] op_sel:[1,0,0]
    v_pk_fma_f32 v[24:25], v[228:229], v[16:17], v[144:145] op_sel_hi:[0,1,1]
    v_pk_fma_f32 v[26:27], v[228:229], v[18:19], v[176:177] op_sel_hi:[0,1,1]
    v_pk_fma_f32 v[20:21], v[228:229], v[18:19], v[24:25] op_sel:[1,0,0] neg_lo:[1,0,0] neg_hi:[1,0,0]
    v_pk_fma_f32 v[22:23], v[228:229], v[16:17], v[26:27] op_sel:[1,0,0]
    v_pk_fma_f32 v[24:25], v[228:229], v[20:21], v[146:147] op_sel_hi:[0,1,1]
    v_pk_fma_f32 v[26:27], v[228:229], v[22:23], v[178:179] op_sel_hi:[0,1,1]
    v_pk_fma_f32 v[16:17], v[228:229], v[22:23], v[24:25] op_sel:[1,0,0] neg_lo:[1,0,0] neg_hi:[1,0,0]
    v_pk_fma_f32 v[18:19], v[228:229], v[20:21], v[26:27] op_sel:[1,0,0]
    v_pk_fma_f32 v[24:25], v[228:229], v[16:17], v[148:149] op_sel_hi:[0,1,1]
    v_pk_fma_f32 v[26:27], v[228:229], v[18:19], v[180:181] op_sel_hi:[0,1,1]
    v_pk_fma_f32 v[20:21], v[228:229], v[18:19], v[24:25] op_sel:[1,0,0] neg_lo:[1,0,0] neg_hi:[1,0,0]
    v_pk_fma_f32 v[22:23], v[228:229], v[16:17], v[26:27] op_sel:[1,0,0]
    v_pk_fma_f32 v[24:25], v[228:229], v[20:21], v[150:151] op_sel_hi:[0,1,1]
    v_pk_fma_f32 v[26:27], v[228:229], v[22:23], v[182:183] op_sel_hi:[0,1,1]
    v_pk_fma_f32 v[16:17], v[228:229], v[22:23], v[24:25] op_sel:[1,0,0] neg_lo:[1,0,0] neg_hi:[1,0,0]
    v_pk_fma_f32 v[18:19], v[228:229], v[20:21], v[26:27] op_sel:[1,0,0]
    v_pk_fma_f32 v[24:25], v[228:229], v[16:17], v[152:153] op_sel_hi:[0,1,1]
    v_pk_fma_f32 v[26:27], v[228:229], v[18:19], v[184:185] op_sel_hi:[0,1,1]
    v_pk_fma_f32 v[20:21], v[228:229], v[18:19], v[24:25] op_sel:[1,0,0] neg_lo:[1,0,0] neg_hi:[1,0,0]
    v_pk_fma_f32 v[22:23], v[228:229], v[16:17], v[26:27] op_sel:[1,0,0]
    v_pk_fma_f32 v[24:25], v[228:229], v[20:21], v[154:155] op_sel_hi:[0,1,1]
    v_pk_fma_f32 v[26:27], v[228:229], v[22:23], v[186:187] op_sel_hi:[0,1,1]
    v_pk_fma_f32 v[16:17], v[228:229], v[22:23], v[24:25] op_sel:[1,0,0] neg_lo:[1,0,0] neg_hi:[1,0,0]
    v_pk_fma_f32 v[18:19], v[228:229], v[20:21], v[26:27] op_sel:[1,0,0]
    v_pk_fma_f32 v[24:25], v[228:229], v[16:17], v[156:157] op_sel_hi:[0,1,1]
    v_pk_fma_f32 v[26:27], v[228:229], v[18:19], v[188:189] op_sel_hi:[0,1,1]
    v_pk_fma_f32 v[20:21], v[228:229], v[18:19], v[24:25] op_sel:[1,0,0] neg_lo:[1,0,0] neg_hi:[1,0,0]
    v_pk_fma_f32 v[22:23], v[228:229], v[16:17], v[26:27] op_sel:[1,0,0]
    v_pk_fma_f32 v[24:25], v[228:229], v[20:21], v[158:159] op_sel_hi:[0,1,1]
    v_pk_fma_f32 v[26:27], v[228:229], v[22:23], v[190:191] op_sel_hi:[0,1,1]
    v_pk_fma_f32 v[16:17], v[228:229], v[22:23], v[24:25] op_sel:[1,0,0] neg_lo:[1,0,0] neg_hi:[1,0,0]
    v_pk_fma_f32 v[18:19], v[228:229], v[20:21], v[26:27] op_sel:[1,0,0]
    v_pk_mov_b32 v[240:241], v[16:17], v[18:19] op_sel:[0,0]
    v_pk_mov_b32 v[20:21], v[16:17], v[18:19] op_sel:[1,1]
    v_pk_fma_f32 v[24:25], v[232:233], v[240:241], v[20:21] op_sel_hi:[0,1,1]
    v_pk_fma_f32 v[20:21], v[232:233], v[240:241], v[24:25] op_sel:[1,1,0] op_sel_hi:[1,0,1] neg_lo:[1,0,0]
    ds_write_b64 v102, v[20:21]
    s_setprio 0
    v_pk_mul_f32 v[192:193], v[230:231], v[160:161] op_sel:[1,0] neg_lo:[1,0] neg_hi:[1,0]
    v_pk_mul_f32 v[194:195], v[230:231], v[128:129] op_sel:[1,0]
    v_pk_fma_f32 v[128:129], v[230:231], v[128:129], v[192:193] op_sel_hi:[0,1,1]
    v_pk_fma_f32 v[160:161], v[230:231], v[160:161], v[194:195] op_sel_hi:[0,1,1]
    v_pk_mul_f32 v[244:245], v[230:231], v[162:163] op_sel:[1,0] neg_lo:[1,0] neg_hi:[1,0]
    v_pk_mul_f32 v[246:247], v[230:231], v[130:131] op_sel:[1,0]
    v_pk_fma_f32 v[130:131], v[230:231], v[130:131], v[244:245] op_sel_hi:[0,1,1]
    v_pk_fma_f32 v[162:163], v[230:231], v[162:163], v[246:247] op_sel_hi:[0,1,1]
    v_pk_mul_f32 v[192:193], v[230:231], v[164:165] op_sel:[1,0] neg_lo:[1,0] neg_hi:[1,0]
    v_pk_mul_f32 v[194:195], v[230:231], v[132:133] op_sel:[1,0]
    v_pk_fma_f32 v[132:133], v[230:231], v[132:133], v[192:193] op_sel_hi:[0,1,1]
    v_pk_fma_f32 v[164:165], v[230:231], v[164:165], v[194:195] op_sel_hi:[0,1,1]
    v_pk_mul_f32 v[244:245], v[230:231], v[166:167] op_sel:[1,0] neg_lo:[1,0] neg_hi:[1,0]
    v_pk_mul_f32 v[246:247], v[230:231], v[134:135] op_sel:[1,0]
    v_pk_fma_f32 v[134:135], v[230:231], v[134:135], v[244:245] op_sel_hi:[0,1,1]
    v_pk_fma_f32 v[166:167], v[230:231], v[166:167], v[246:247] op_sel_hi:[0,1,1]
    v_pk_mul_f32 v[192:193], v[230:231], v[168:169] op_sel:[1,0] neg_lo:[1,0] neg_hi:[1,0]
    v_pk_mul_f32 v[194:195], v[230:231], v[136:137] op_sel:[1,0]
    v_pk_fma_f32 v[136:137], v[230:231], v[136:137], v[192:193] op_sel_hi:[0,1,1]
    v_pk_fma_f32 v[168:169], v[230:231], v[168:169], v[194:195] op_sel_hi:[0,1,1]
    v_pk_mul_f32 v[244:245], v[230:231], v[170:171] op_sel:[1,0] neg_lo:[1,0] neg_hi:[1,0]
    v_pk_mul_f32 v[246:247], v[230:231], v[138:139] op_sel:[1,0]
    v_pk_fma_f32 v[138:139], v[230:231], v[138:139], v[244:245] op_sel_hi:[0,1,1]
    v_pk_fma_f32 v[170:171], v[230:231], v[170:171], v[246:247] op_sel_hi:[0,1,1]
    v_pk_mul_f32 v[192:193], v[230:231], v[172:173] op_sel:[1,0] neg_lo:[1,0] neg_hi:[1,0]
    v_pk_mul_f32 v[194:195], v[230:231], v[140:141] op_sel:[1,0]
    v_pk_fma_f32 v[140:141], v[230:231], v[140:141], v[192:193] op_sel_hi:[0,1,1]
    v_pk_fma_f32 v[172:173], v[230:231], v[172:173], v[194:195] op_sel_hi:[0,1,1]
    v_pk_mul_f32 v[244:245], v[230:231], v[174:175] op_sel:[1,0] neg_lo:[1,0] neg_hi:[1,0]
    v_pk_mul_f32 v[246:247], v[230:231], v[142:143] op_sel:[1,0]
    v_pk_fma_f32 v[142:143], v[230:231], v[142:143], v[244:245] op_sel_hi:[0,1,1]
    v_pk_fma_f32 v[174:175], v[230:231], v[174:175], v[246:247] op_sel_hi:[0,1,1]
    v_pk_mul_f32 v[192:193], v[230:231], v[176:177] op_sel:[1,0] neg_lo:[1,0] neg_hi:[1,0]
    v_pk_mul_f32 v[194:195], v[230:231], v[144:145] op_sel:[1,0]
    v_pk_fma_f32 v[144:145], v[230:231], v[144:145], v[192:193] op_sel_hi:[0,1,1]
    v_pk_fma_f32 v[176:177], v[230:231], v[176:177], v[194:195] op_sel_hi:[0,1,1]
    v_pk_mul_f32 v[244:245], v[230:231], v[178:179] op_sel:[1,0] neg_lo:[1,0] neg_hi:[1,0]
    v_pk_mul_f32 v[246:247], v[230:231], v[146:147] op_sel:[1,0]
    v_pk_fma_f32 v[146:147], v[230:231], v[146:147], v[244:245] op_sel_hi:[0,1,1]
    v_pk_fma_f32 v[178:179], v[230:231], v[178:179], v[246:247] op_sel_hi:[0,1,1]
    v_pk_mul_f32 v[192:193], v[230:231], v[180:181] op_sel:[1,0] neg_lo:[1,0] neg_hi:[1,0]
    v_pk_mul_f32 v[194:195], v[230:231], v[148:149] op_sel:[1,0]
    v_pk_fma_f32 v[148:149], v[230:231], v[148:149], v[192:193] op_sel_hi:[0,1,1]
    v_pk_fma_f32 v[180:181], v[230:231], v[180:181], v[194:195] op_sel_hi:[0,1,1]
    v_pk_mul_f32 v[244:245], v[230:231], v[182:183] op_sel:[1,0] neg_lo:[1,0] neg_hi:[1,0]
    v_pk_mul_f32 v[246:247], v[230:231], v[150:151] op_sel:[1,0]
    v_pk_fma_f32 v[150:151], v[230:231], v[150:151], v[244:245] op_sel_hi:[0,1,1]
    v_pk_fma_f32 v[182:183], v[230:231], v[182:183], v[246:247] op_sel_hi:[0,1,1]
    v_pk_mul_f32 v[192:193], v[230:231], v[184:185] op_sel:[1,0] neg_lo:[1,0] neg_hi:[1,0]
    v_pk_mul_f32 v[194:195], v[230:231], v[152:153] op_sel:[1,0]
    v_pk_fma_f32 v[152:153], v[230:231], v[152:153], v[192:193] op_sel_hi:[0,1,1]
    v_pk_fma_f32 v[184:185], v[230:231], v[184:185], v[194:195] op_sel_hi:[0,1,1]
    v_pk_mul_f32 v[244:245], v[230:231], v[186:187] op_sel:[1,0] neg_lo:[1,0] neg_hi:[1,0]
    v_pk_mul_f32 v[246:247], v[230:231], v[154:155] op_sel:[1,0]
    v_pk_fma_f32 v[154:155], v[230:231], v[154:155], v[244:245] op_sel_hi:[0,1,1]
    v_pk_fma_f32 v[186:187], v[230:231], v[186:187], v[246:247] op_sel_hi:[0,1,1]
    v_pk_mul_f32 v[192:193], v[230:231], v[188:189] op_sel:[1,0] neg_lo:[1,0] neg_hi:[1,0]
    v_pk_mul_f32 v[194:195], v[230:231], v[156:157] op_sel:[1,0]
    v_pk_fma_f32 v[156:157], v[230:231], v[156:157], v[192:193] op_sel_hi:[0,1,1]
    v_pk_fma_f32 v[188:189], v[230:231], v[188:189], v[194:195] op_sel_hi:[0,1,1]
    v_pk_mul_f32 v[244:245], v[230:231], v[190:191] op_sel:[1,0] neg_lo:[1,0] neg_hi:[1,0]
    v_pk_mul_f32 v[246:247], v[230:231], v[158:159] op_sel:[1,0]
    v_pk_fma_f32 v[158:159], v[230:231], v[158:159], v[244:245] op_sel_hi:[0,1,1]
    v_pk_fma_f32 v[190:191], v[230:231], v[190:191], v[246:247] op_sel_hi:[0,1,1]
    s_setprio 1
    s_waitcnt lgkmcnt(0)
    s_barrier
    ds_read_b64 v[208:209], v101
    ds_read_b64 v[192:193], v103 offset:0
    ds_read_b64 v[194:195], v103 offset:256
    ds_read_b64 v[196:197], v103 offset:512
    ds_read_b64 v[198:199], v103 offset:768
    ds_read_b64 v[200:201], v103 offset:1024
    ds_read_b64 v[202:203], v103 offset:1280
    ds_read_b64 v[204:205], v103 offset:1536
    ds_read_b64 v[206:207], v103 offset:1792
    v_cmp_lt_u32 vcc, 31, v1
    s_waitcnt lgkmcnt(6)
    v_pk_fma_f32 v[210:211], v[234:235], v[192:193], v[194:195] op_sel_hi:[0,1,1]
    v_pk_fma_f32 v[194:195], v[234:235], v[192:193], v[210:211] op_sel:[1,1,0] op_sel_hi:[1,0,1] neg_lo:[1,0,0]
    s_waitcnt lgkmcnt(5)
    v_pk_fma_f32 v[210:211], v[234:235], v[194:195], v[196:197] op_sel_hi:[0,1,1]
    v_pk_fma_f32 v[196:197], v[234:235], v[194:195], v[210:211] op_sel:[1,1,0] op_sel_hi:[1,0,1] neg_lo:[1,0,0]
    s_waitcnt lgkmcnt(4)
    v_pk_fma_f32 v[210:211], v[234:235], v[196:197], v[198:199] op_sel_hi:[0,1,1]
    v_pk_fma_f32 v[198:199], v[234:235], v[196:197], v[210:211] op_sel:[1,1,0] op_sel_hi:[1,0,1] neg_lo:[1,0,0]
    s_waitcnt lgkmcnt(3)
    v_pk_fma_f32 v[210:211], v[234:235], v[198:199], v[200:201] op_sel_hi:[0,1,1]
    v_pk_fma_f32 v[200:201], v[234:235], v[198:199], v[210:211] op_sel:[1,1,0] op_sel_hi:[1,0,1] neg_lo:[1,0,0]
    s_waitcnt lgkmcnt(2)
    v_pk_fma_f32 v[210:211], v[234:235], v[200:201], v[202:203] op_sel_hi:[0,1,1]
    v_pk_fma_f32 v[202:203], v[234:235], v[200:201], v[210:211] op_sel:[1,1,0] op_sel_hi:[1,0,1] neg_lo:[1,0,0]
    s_waitcnt lgkmcnt(1)
    v_pk_fma_f32 v[210:211], v[234:235], v[202:203], v[204:205] op_sel_hi:[0,1,1]
    v_pk_fma_f32 v[204:205], v[234:235], v[202:203], v[210:211] op_sel:[1,1,0] op_sel_hi:[1,0,1] neg_lo:[1,0,0]
    s_waitcnt lgkmcnt(0)
    v_pk_fma_f32 v[210:211], v[234:235], v[204:205], v[206:207] op_sel_hi:[0,1,1]
    v_pk_fma_f32 v[206:207], v[234:235], v[204:205], v[210:211] op_sel:[1,1,0] op_sel_hi:[1,0,1] neg_lo:[1,0,0]
    s_cmp_lg_u32 s3, 4
    s_cbranch_scc1 L_e1
    s_lshl_b32 s34, s76, 9
    s_mov_b32 exec_hi, 0
    buffer_store_dwordx4 v[206:209], v127, s[8:11], s34 offen sc1
    s_mov_b64 exec, -1
    v_cndmask_b32 v242, 0, v192, vcc
    v_cndmask_b32 v243, 0, v193, vcc
    s_branch L_att
L_e1:
    v_cndmask_b32 v242, v194, v196, vcc
    v_cndmask_b32 v243, v195, v197, vcc
    s_cmp_eq_u32 s37, 1
    s_cbranch_scc1 L_att
    v_cndmask_b32 v242, v198, v200, vcc
    v_cndmask_b32 v243, v199, v201, vcc
    s_cmp_eq_u32 s37, 2
    s_cbranch_scc1 L_att
    v_cndmask_b32 v242, v202, v204, vcc
    v_cndmask_b32 v243, v203, v205, vcc
L_att:
    s_setprio 1
    s_cmp_ge_u32 s3, 4
    s_cbranch_scc1 L_pr0
    s_setprio 0
L_pr0:
    v_mov_b32 v88, 0
    v_mov_b32 v89, 0
    v_mov_b32 v90, 0
    v_mov_b32 v91, 0
    s_lshl_b32 s34, s3, 11
    s_add_u32 s34, s34, 98304
    v_add_u32 v13, s34, v114
    v_mov_b32 v14, 116736
    ds_read_b128 v[2:5], v13
    ds_read_b128 v[56:59], v116 offset:0
    ds_read_b128 v[6:9], v13 offset:1024
    ds_read_b128 v[60:63], v116 offset:1024
    ds_read_b128 v[64:67], v116 offset:2048
    ds_read_b64 v[14:15], v14
    s_waitcnt lgkmcnt(4)
    v_mfma_f32_32x32x16_bf16 v[16:31], v[56:59], v[2:5], 0
    ds_read_b128 v[56:59], v116 offset:4096
    s_waitcnt lgkmcnt(3)
    v_mfma_f32_32x32x16_bf16 v[16:31], v[60:63], v[6:9], v[16:31]
    ds_read_b128 v[60:63], v116 offset:5120
    s_waitcnt lgkmcnt(2)
    v_readfirstlane_b32 s40, v14
    v_readfirstlane_b32 s41, v15
    s_waitcnt lgkmcnt(0)
    s_mov_b32 s94, s87
    s_add_u32 s34, s24, 1
    s_and_b32 s34, s34, 7
    s_lshl_b32 s34, s34, 15
    s_lshl_b32 s35, s25, 10
    s_add_u32 s34, s34, s35
    s_add_u32 s34, s34, 50331648
    v_and_b32 v115, 3, v1
    v_lshlrev_b32 v115, 7, v115
    v_add_u32 v115, s34, v115
    s_waitcnt lgkmcnt(1)
    v_mfma_f32_32x32x16_bf16 v[32:47], v[56:59], v[2:5], 0
    ds_read_b128 v[56:59], v116 offset:8192
    v_exp_f32 v16, v16
    v_exp_f32 v17, v17
    v_exp_f32 v18, v18
    ds_read_b128 v[68:71], v116 offset:3072
    v_exp_f32 v19, v19
    v_exp_f32 v20, v20
    v_exp_f32 v21, v21
    v_exp_f32 v22, v22
    v_mfma_f32_32x32x16_bf16 v[32:47], v[60:63], v[6:9], v[32:47]
    ds_read_b128 v[60:63], v116 offset:9216
    v_exp_f32 v23, v23
    v_exp_f32 v24, v24
    v_cvt_pk_bf16_f32 v48, v16, v17
    v_cvt_pk_bf16_f32 v49, v18, v19
    v_cvt_pk_bf16_f32 v50, v20, v21
    v_cvt_pk_bf16_f32 v51, v22, v23
    s_waitcnt lgkmcnt(3)
    v_exp_f32 v25, v25
    v_exp_f32 v26, v26
    v_mfma_f32_32x32x16_bf16 v[72:87], v[64:67], v[48:51], 0
    ds_read_b128 v[64:67], v116 offset:6144
    v_exp_f32 v27, v27
    v_exp_f32 v28, v28
    v_exp_f32 v29, v29
    v_exp_f32 v30, v30
    v_exp_f32 v31, v31
    v_cvt_pk_bf16_f32 v52, v24, v25
    v_cvt_pk_bf16_f32 v53, v26, v27
    v_cvt_pk_bf16_f32 v54, v28, v29
    v_cvt_pk_bf16_f32 v55, v30, v31
    s_cmp_ge_u32 s3, 4
    s_cbranch_scc1 L_tu0
    s_branch L_te0
L_tu0:
L_te0:
    s_waitcnt lgkmcnt(1)
    v_mfma_f32_32x32x16_bf16 v[16:31], v[56:59], v[2:5], 0
    ds_read_b128 v[56:59], v116 offset:12288
    v_exp_f32 v32, v32
    v_exp_f32 v33, v33
    v_exp_f32 v34, v34
    v_mfma_f32_32x32x16_bf16 v[72:87], v[68:71], v[52:55], v[72:87]
    ds_read_b128 v[68:71], v116 offset:7168
    v_exp_f32 v35, v35
    v_exp_f32 v36, v36
    v_exp_f32 v37, v37
    v_smfmac_f32_16x16x64_bf16 v[88:91], v[92:95], v[48:55], v0
    v_exp_f32 v38, v38
    v_mfma_f32_32x32x16_bf16 v[16:31], v[60:63], v[6:9], v[16:31]
    ds_read_b128 v[60:63], v116 offset:13312
    v_exp_f32 v39, v39
    v_exp_f32 v40, v40
    v_cvt_pk_bf16_f32 v48, v32, v33
    v_cvt_pk_bf16_f32 v49, v34, v35
    v_cvt_pk_bf16_f32 v50, v36, v37
    v_cvt_pk_bf16_f32 v51, v38, v39
    s_waitcnt lgkmcnt(3)
    v_exp_f32 v41, v41
    v_exp_f32 v42, v42
    v_mfma_f32_32x32x16_bf16 v[72:87], v[64:67], v[48:51], v[72:87]
    ds_read_b128 v[64:67], v116 offset:10240
    v_exp_f32 v43, v43
    v_exp_f32 v44, v44
    v_exp_f32 v45, v45
    v_exp_f32 v46, v46
    v_exp_f32 v47, v47
    v_cvt_pk_bf16_f32 v52, v40, v41
    v_cvt_pk_bf16_f32 v53, v42, v43
    v_cvt_pk_bf16_f32 v54, v44, v45
    v_cvt_pk_bf16_f32 v55, v46, v47
    s_cmp_ge_u32 s3, 4
    s_cbranch_scc1 L_tu1
    s_waitcnt vmcnt(0)
    s_lshl3_add_u32 s34, s76, s3
    s_lshl_b32 s34, s34, 7
    s_add_u32 s34, s34, 50331648
    v_mov_b32 v13, s34
    v_mov_b32 v14, s40
    v_mov_b32 v15, s41
    s_mov_b64 exec, 1
    buffer_store_dwordx2 v[14:15], v13, s[8:11], 0 offen sc1
    s_mov_b64 exec, -1
    s_branch L_te1
L_tu1:
L_te1:
    s_waitcnt lgkmcnt(1)
    v_mfma_f32_32x32x16_bf16 v[32:47], v[56:59], v[2:5], 0
    ds_read_b128 v[56:59], v116 offset:16384
    v_exp_f32 v16, v16
    v_exp_f32 v17, v17
    v_exp_f32 v18, v18
    v_mfma_f32_32x32x16_bf16 v[72:87], v[68:71], v[52:55], v[72:87]
    ds_read_b128 v[68:71], v116 offset:11264
    v_exp_f32 v19, v19
    v_exp_f32 v20, v20
    v_exp_f32 v21, v21
    v_smfmac_f32_16x16x64_bf16 v[88:91], v[92:95], v[48:55], v0
    v_exp_f32 v22, v22
    v_mfma_f32_32x32x16_bf16 v[32:47], v[60:63], v[6:9], v[32:47]
    ds_read_b128 v[60:63], v116 offset:17408
    v_exp_f32 v23, v23
    v_exp_f32 v24, v24
    v_cvt_pk_bf16_f32 v48, v16, v17
    v_cvt_pk_bf16_f32 v49, v18, v19
    v_cvt_pk_bf16_f32 v50, v20, v21
    v_cvt_pk_bf16_f32 v51, v22, v23
    s_waitcnt lgkmcnt(3)
    v_exp_f32 v25, v25
    v_exp_f32 v26, v26
    v_mfma_f32_32x32x16_bf16 v[72:87], v[64:67], v[48:51], v[72:87]
    ds_read_b128 v[64:67], v116 offset:14336
    v_exp_f32 v27, v27
    v_exp_f32 v28, v28
    v_exp_f32 v29, v29
    v_exp_f32 v30, v30
    v_exp_f32 v31, v31
    v_cvt_pk_bf16_f32 v52, v24, v25
    v_cvt_pk_bf16_f32 v53, v26, v27
    v_cvt_pk_bf16_f32 v54, v28, v29
    v_cvt_pk_bf16_f32 v55, v30, v31
    s_cmp_ge_u32 s3, 4
    s_cbranch_scc1 L_tu2
    s_branch L_te2
L_tu2:
L_te2:
    s_waitcnt lgkmcnt(1)
    v_mfma_f32_32x32x16_bf16 v[16:31], v[56:59], v[2:5], 0
    ds_read_b128 v[56:59], v116 offset:20480
    v_exp_f32 v32, v32
    v_exp_f32 v33, v33
    v_exp_f32 v34, v34
    v_mfma_f32_32x32x16_bf16 v[72:87], v[68:71], v[52:55], v[72:87]
    ds_read_b128 v[68:71], v116 offset:15360
    v_exp_f32 v35, v35
    v_exp_f32 v36, v36
    v_exp_f32 v37, v37
    v_smfmac_f32_16x16x64_bf16 v[88:91], v[92:95], v[48:55], v0
    v_exp_f32 v38, v38
    v_mfma_f32_32x32x16_bf16 v[16:31], v[60:63], v[6:9], v[16:31]
    ds_read_b128 v[60:63], v116 offset:21504
    v_exp_f32 v39, v39
    v_exp_f32 v40, v40
    v_cvt_pk_bf16_f32 v48, v32, v33
    v_cvt_pk_bf16_f32 v49, v34, v35
    v_cvt_pk_bf16_f32 v50, v36, v37
    v_cvt_pk_bf16_f32 v51, v38, v39
    s_waitcnt lgkmcnt(3)
    v_exp_f32 v41, v41
    v_exp_f32 v42, v42
    v_mfma_f32_32x32x16_bf16 v[72:87], v[64:67], v[48:51], v[72:87]
    ds_read_b128 v[64:67], v116 offset:18432
    v_exp_f32 v43, v43
    v_exp_f32 v44, v44
    v_exp_f32 v45, v45
    v_exp_f32 v46, v46
    v_exp_f32 v47, v47
    v_cvt_pk_bf16_f32 v52, v40, v41
    v_cvt_pk_bf16_f32 v53, v42, v43
    v_cvt_pk_bf16_f32 v54, v44, v45
    v_cvt_pk_bf16_f32 v55, v46, v47
    s_cmp_ge_u32 s3, 4
    s_cbranch_scc1 L_tu3
    buffer_load_dwordx2 v[252:253], v115, s[8:11], 0 offen sc1
    v_mov_b32 v136, 0
    v_mov_b32 v137, 0
    v_mov_b32 v138, 0
    v_mov_b32 v139, 0
    v_lshlrev_b32 v128, 16, v240
    v_and_b32 v129, 0xffff0000, v240
    v_lshlrev_b32 v130, 16, v224
    v_and_b32 v131, 0xffff0000, v224
    v_pk_mul_f32 v[130:131], v[130:131], v[128:129]
    v_cvt_pk_bf16_f32 v131, v130, v131
    v_lshlrev_b32 v130, 16, v131
    v_and_b32 v131, 0xffff0000, v131
    v_pk_add_f32 v[136:137], v[136:137], v[130:131]
    v_lshlrev_b32 v132, 16, v232
    v_and_b32 v133, 0xffff0000, v232
    v_pk_mul_f32 v[132:133], v[132:133], v[128:129]
    v_cvt_pk_bf16_f32 v133, v132, v133
    v_lshlrev_b32 v132, 16, v133
    v_and_b32 v133, 0xffff0000, v133
    v_pk_add_f32 v[138:139], v[138:139], v[132:133]
    v_lshlrev_b32 v128, 16, v241
    v_and_b32 v129, 0xffff0000, v241
    v_lshlrev_b32 v130, 16, v225
    v_and_b32 v131, 0xffff0000, v225
    v_pk_mul_f32 v[130:131], v[130:131], v[128:129]
    v_cvt_pk_bf16_f32 v131, v130, v131
    v_lshlrev_b32 v130, 16, v131
    v_and_b32 v131, 0xffff0000, v131
    v_pk_add_f32 v[136:137], v[136:137], v[130:131]
    v_lshlrev_b32 v132, 16, v233
    v_and_b32 v133, 0xffff0000, v233
    v_pk_mul_f32 v[132:133], v[132:133], v[128:129]
    v_cvt_pk_bf16_f32 v133, v132, v133
    v_lshlrev_b32 v132, 16, v133
    v_and_b32 v133, 0xffff0000, v133
    v_pk_add_f32 v[138:139], v[138:139], v[132:133]
    v_lshlrev_b32 v128, 16, v242
    v_and_b32 v129, 0xffff0000, v242
    v_lshlrev_b32 v130, 16, v226
    v_and_b32 v131, 0xffff0000, v226
    v_pk_mul_f32 v[130:131], v[130:131], v[128:129]
    v_cvt_pk_bf16_f32 v131, v130, v131
    v_lshlrev_b32 v130, 16, v131
    v_and_b32 v131, 0xffff0000, v131
    v_pk_add_f32 v[136:137], v[136:137], v[130:131]
    v_lshlrev_b32 v132, 16, v234
    v_and_b32 v133, 0xffff0000, v234
    v_pk_mul_f32 v[132:133], v[132:133], v[128:129]
    v_cvt_pk_bf16_f32 v133, v132, v133
    v_lshlrev_b32 v132, 16, v133
    v_and_b32 v133, 0xffff0000, v133
    v_pk_add_f32 v[138:139], v[138:139], v[132:133]
    v_lshlrev_b32 v128, 16, v243
    v_and_b32 v129, 0xffff0000, v243
    v_lshlrev_b32 v130, 16, v227
    v_and_b32 v131, 0xffff0000, v227
    v_pk_mul_f32 v[130:131], v[130:131], v[128:129]
    v_cvt_pk_bf16_f32 v131, v130, v131
    v_lshlrev_b32 v130, 16, v131
    v_and_b32 v131, 0xffff0000, v131
    v_pk_add_f32 v[136:137], v[136:137], v[130:131]
    v_lshlrev_b32 v132, 16, v235
    v_and_b32 v133, 0xffff0000, v235
    v_pk_mul_f32 v[132:133], v[132:133], v[128:129]
    v_cvt_pk_bf16_f32 v133, v132, v133
    v_lshlrev_b32 v132, 16, v133
    v_and_b32 v133, 0xffff0000, v133
    v_pk_add_f32 v[138:139], v[138:139], v[132:133]
    v_lshlrev_b32 v128, 16, v244
    v_and_b32 v129, 0xffff0000, v244
    v_lshlrev_b32 v130, 16, v228
    v_and_b32 v131, 0xffff0000, v228
    v_pk_mul_f32 v[130:131], v[130:131], v[128:129]
    v_cvt_pk_bf16_f32 v131, v130, v131
    v_lshlrev_b32 v130, 16, v131
    v_and_b32 v131, 0xffff0000, v131
    v_pk_add_f32 v[136:137], v[136:137], v[130:131]
    v_lshlrev_b32 v132, 16, v236
    v_and_b32 v133, 0xffff0000, v236
    v_pk_mul_f32 v[132:133], v[132:133], v[128:129]
    v_cvt_pk_bf16_f32 v133, v132, v133
    v_lshlrev_b32 v132, 16, v133
    v_and_b32 v133, 0xffff0000, v133
    v_pk_add_f32 v[138:139], v[138:139], v[132:133]
    v_lshlrev_b32 v128, 16, v245
    v_and_b32 v129, 0xffff0000, v245
    v_lshlrev_b32 v130, 16, v229
    v_and_b32 v131, 0xffff0000, v229
    v_pk_mul_f32 v[130:131], v[130:131], v[128:129]
    v_cvt_pk_bf16_f32 v131, v130, v131
    v_lshlrev_b32 v130, 16, v131
    v_and_b32 v131, 0xffff0000, v131
    v_pk_add_f32 v[136:137], v[136:137], v[130:131]
    v_lshlrev_b32 v132, 16, v237
    v_and_b32 v133, 0xffff0000, v237
    v_pk_mul_f32 v[132:133], v[132:133], v[128:129]
    v_cvt_pk_bf16_f32 v133, v132, v133
    v_lshlrev_b32 v132, 16, v133
    v_and_b32 v133, 0xffff0000, v133
    v_pk_add_f32 v[138:139], v[138:139], v[132:133]
    v_lshlrev_b32 v128, 16, v246
    v_and_b32 v129, 0xffff0000, v246
    v_lshlrev_b32 v130, 16, v230
    v_and_b32 v131, 0xffff0000, v230
    v_pk_mul_f32 v[130:131], v[130:131], v[128:129]
    v_cvt_pk_bf16_f32 v131, v130, v131
    v_lshlrev_b32 v130, 16, v131
    v_and_b32 v131, 0xffff0000, v131
    v_pk_add_f32 v[136:137], v[136:137], v[130:131]
    v_lshlrev_b32 v132, 16, v238
    v_and_b32 v133, 0xffff0000, v238
    v_pk_mul_f32 v[132:133], v[132:133], v[128:129]
    v_cvt_pk_bf16_f32 v133, v132, v133
    v_lshlrev_b32 v132, 16, v133
    v_and_b32 v133, 0xffff0000, v133
    v_pk_add_f32 v[138:139], v[138:139], v[132:133]
    v_lshlrev_b32 v128, 16, v247
    v_and_b32 v129, 0xffff0000, v247
    v_lshlrev_b32 v130, 16, v231
    v_and_b32 v131, 0xffff0000, v231
    v_pk_mul_f32 v[130:131], v[130:131], v[128:129]
    v_cvt_pk_bf16_f32 v131, v130, v131
    v_lshlrev_b32 v130, 16, v131
    v_and_b32 v131, 0xffff0000, v131
    v_pk_add_f32 v[136:137], v[136:137], v[130:131]
    v_lshlrev_b32 v132, 16, v239
    v_and_b32 v133, 0xffff0000, v239
    v_pk_mul_f32 v[132:133], v[132:133], v[128:129]
    v_cvt_pk_bf16_f32 v133, v132, v133
    v_lshlrev_b32 v132, 16, v133
    v_and_b32 v133, 0xffff0000, v133
    v_pk_add_f32 v[138:139], v[138:139], v[132:133]
    v_add_f32 v136, v136, v137
    v_add_f32 v137, v138, v139
    s_nop 0
    v_add_f32_dpp v136, v136, v136 quad_perm:[1,0,3,2] row_mask:0xf bank_mask:0xf
    v_add_f32_dpp v137, v137, v137 quad_perm:[1,0,3,2] row_mask:0xf bank_mask:0xf
    s_nop 0
    v_add_f32_dpp v136, v136, v136 quad_perm:[2,3,0,1] row_mask:0xf bank_mask:0xf
    v_add_f32_dpp v137, v137, v137 quad_perm:[2,3,0,1] row_mask:0xf bank_mask:0xf
    s_nop 0
    v_add_f32_dpp v136, v136, v136 row_half_mirror row_mask:0xf bank_mask:0xf
    v_add_f32_dpp v137, v137, v137 row_half_mirror row_mask:0xf bank_mask:0xf
    s_nop 0
    v_add_f32_dpp v136, v136, v136 row_mirror row_mask:0xf bank_mask:0xf
    v_add_f32_dpp v137, v137, v137 row_mirror row_mask:0xf bank_mask:0xf
    v_readlane_b32 s34, v136, 16
    v_readlane_b32 s35, v136, 32
    v_readlane_b32 s36, v136, 48
    v_add_f32 v136, s34, v136
    v_add_f32 v136, s35, v136
    v_add_f32 v136, s36, v136
    v_cvt_pk_bf16_f32 v136, v136, v136
    v_and_b32 v136, 0xffff0000, v136
    v_mul_f32 v136, 0xbfb8aa3b, v136
    v_exp_f32 v136, v136
    s_nop 0
    v_add_f32 v136, 1.0, v136
    v_rcp_f32 v136, v136
    s_nop 0
    v_cvt_pk_bf16_f32 v136, v136, v136
    v_and_b32 v136, 0xffff0000, v136
    v_readlane_b32 s34, v137, 16
    v_readlane_b32 s35, v137, 32
    v_readlane_b32 s36, v137, 48
    v_add_f32 v137, s34, v137
    v_add_f32 v137, s35, v137
    v_add_f32 v137, s36, v137
    v_cvt_pk_bf16_f32 v137, v137, v137
    v_and_b32 v137, 0xffff0000, v137
    v_mul_f32 v137, 0xbfb8aa3b, v137
    v_exp_f32 v137, v137
    s_nop 0
    v_add_f32 v137, 1.0, v137
    v_rcp_f32 v137, v137
    s_nop 0
    v_cvt_pk_bf16_f32 v137, v137, v137
    v_and_b32 v137, 0xffff0000, v137
    s_lshl_b32 s34, s3, 3
    s_add_u32 s34, s34, s77
    s_add_u32 s34, s34, 196608
    v_mov_b32 v13, s34
    s_mov_b64 exec, 1
    buffer_store_dwordx2 v[136:137], v13, s[8:11], 0 offen sc1
    s_mov_b64 exec, -1
    s_cmp_lg_u32 s94, 0
    s_cbranch_scc1 L_c1d1
    s_waitcnt vmcnt(1)
    v_cmp_ne_u64 vcc, s[40:41], v[252:253]
    s_cbranch_vccz L_c1y1
    buffer_load_dwordx2 v[252:253], v115, s[8:11], 0 offen sc1
    s_branch L_c1d1
L_c1y1:
    s_mov_b32 s94, 1
    s_mov_b32 s34, s78
    s_add_u32 m0, s80, 0
    s_add_u32 s35, s34, 8192
    s_and_b32 s35, s35, 0x3ffff
    buffer_load_dwordx4 v125, s[8:11], s35 offen sc1 lds
    s_add_u32 m0, s80, 4096
    s_add_u32 s35, s34, 12288
    s_and_b32 s35, s35, 0x3ffff
    buffer_load_dwordx4 v125, s[8:11], s35 offen sc1 lds
    s_add_u32 m0, s80, 8192
    s_add_u32 s35, s34, 16384
    s_and_b32 s35, s35, 0x3ffff
    buffer_load_dwordx4 v125, s[8:11], s35 offen sc1 lds
    s_add_u32 m0, s80, 12288
    s_add_u32 s35, s34, 20480
    s_and_b32 s35, s35, 0x3ffff
    buffer_load_dwordx4 v125, s[8:11], s35 offen sc1 lds
    s_add_u32 m0, s80, 16384
    s_add_u32 s35, s34, 24576
    s_and_b32 s35, s35, 0x3ffff
    buffer_load_dwordx4 v125, s[8:11], s35 offen sc1 lds
    s_add_u32 m0, s80, 20480
    s_add_u32 s35, s34, 28672
    s_and_b32 s35, s35, 0x3ffff
    buffer_load_dwordx4 v125, s[8:11], s35 offen sc1 lds
    s_add_u32 m0, s80, 24576
    s_add_u32 s35, s34, 32768
    s_and_b32 s35, s35, 0x3ffff
    buffer_load_dwordx4 v125, s[8:11], s35 offen sc1 lds
    s_add_u32 m0, s80, 28672
    s_add_u32 s35, s34, 36864
    s_and_b32 s35, s35, 0x3ffff
    buffer_load_dwordx4 v125, s[8:11], s35 offen sc1 lds
L_c1d1:
    s_branch L_te3
L_tu3:
    s_lshl_b32 s34, s25, 9
    s_cmp_le_u32 s24, 0
    s_cbranch_scc1 L_le0
    buffer_load_dwordx4 v[196:199], v127, s[8:11], s34 offen sc1
    s_add_u32 s34, s34, 0x4000
    s_cmp_le_u32 s24, 1
    s_cbranch_scc1 L_le0
    buffer_load_dwordx4 v[200:203], v127, s[8:11], s34 offen sc1
    s_add_u32 s34, s34, 0x4000
    s_cmp_le_u32 s24, 2
    s_cbranch_scc1 L_le0
    buffer_load_dwordx4 v[204:207], v127, s[8:11], s34 offen sc1
    s_add_u32 s34, s34, 0x4000
    s_cmp_le_u32 s24, 3
    s_cbranch_scc1 L_le0
    buffer_load_dwordx4 v[208:211], v127, s[8:11], s34 offen sc1
    s_add_u32 s34, s34, 0x4000
    s_cmp_le_u32 s24, 4
    s_cbranch_scc1 L_le0
    buffer_load_dwordx4 v[212:215], v127, s[8:11], s34 offen sc1
    s_add_u32 s34, s34, 0x4000
    s_cmp_le_u32 s24, 5
    s_cbranch_scc1 L_le0
    buffer_load_dwordx4 v[216:219], v127, s[8:11], s34 offen sc1
    s_add_u32 s34, s34, 0x4000
    s_cmp_le_u32 s24, 6
    s_cbranch_scc1 L_le0
    buffer_load_dwordx4 v[220:223], v127, s[8:11], s34 offen sc1
    s_add_u32 s34, s34, 0x4000
L_le0:
L_te3:
    s_waitcnt lgkmcnt(1)
    v_mfma_f32_32x32x16_bf16 v[32:47], v[56:59], v[2:5], 0
    ds_read_b128 v[56:59], v116 offset:24576
    v_exp_f32 v16, v16
    v_exp_f32 v17, v17
    v_exp_f32 v18, v18
    v_mfma_f32_32x32x16_bf16 v[72:87], v[68:71], v[52:55], v[72:87]
    ds_read_b128 v[68:71], v116 offset:19456
    v_exp_f32 v19, v19
    v_exp_f32 v20, v20
    v_exp_f32 v21, v21
    v_smfmac_f32_16x16x64_bf16 v[88:91], v[92:95], v[48:55], v0
    v_exp_f32 v22, v22
    v_mfma_f32_32x32x16_bf16 v[32:47], v[60:63], v[6:9], v[32:47]
    ds_read_b128 v[60:63], v116 offset:25600
    v_exp_f32 v23, v23
    v_exp_f32 v24, v24
    v_cvt_pk_bf16_f32 v48, v16, v17
    v_cvt_pk_bf16_f32 v49, v18, v19
    v_cvt_pk_bf16_f32 v50, v20, v21
    v_cvt_pk_bf16_f32 v51, v22, v23
    s_waitcnt lgkmcnt(3)
    v_exp_f32 v25, v25
    v_exp_f32 v26, v26
    v_mfma_f32_32x32x16_bf16 v[72:87], v[64:67], v[48:51], v[72:87]
    ds_read_b128 v[64:67], v116 offset:22528
    v_exp_f32 v27, v27
    v_exp_f32 v28, v28
    v_exp_f32 v29, v29
    v_exp_f32 v30, v30
    v_exp_f32 v31, v31
    v_cvt_pk_bf16_f32 v52, v24, v25
    v_cvt_pk_bf16_f32 v53, v26, v27
    v_cvt_pk_bf16_f32 v54, v28, v29
    v_cvt_pk_bf16_f32 v55, v30, v31
    s_cmp_ge_u32 s3, 4
    s_cbranch_scc1 L_tu4
    s_cmp_lg_u32 s94, 0
    s_cbranch_scc1 L_c1d2
    s_waitcnt vmcnt(0)
    v_cmp_ne_u64 vcc, s[40:41], v[252:253]
    s_cbranch_vccz L_c1y2
    buffer_load_dwordx2 v[252:253], v115, s[8:11], 0 offen sc1
    s_branch L_c1d2
L_c1y2:
    s_mov_b32 s94, 1
    s_mov_b32 s34, s78
    s_add_u32 m0, s80, 0
    s_add_u32 s35, s34, 8192
    s_and_b32 s35, s35, 0x3ffff
    buffer_load_dwordx4 v125, s[8:11], s35 offen sc1 lds
    s_add_u32 m0, s80, 4096
    s_add_u32 s35, s34, 12288
    s_and_b32 s35, s35, 0x3ffff
    buffer_load_dwordx4 v125, s[8:11], s35 offen sc1 lds
    s_add_u32 m0, s80, 8192
    s_add_u32 s35, s34, 16384
    s_and_b32 s35, s35, 0x3ffff
    buffer_load_dwordx4 v125, s[8:11], s35 offen sc1 lds
    s_add_u32 m0, s80, 12288
    s_add_u32 s35, s34, 20480
    s_and_b32 s35, s35, 0x3ffff
    buffer_load_dwordx4 v125, s[8:11], s35 offen sc1 lds
    s_add_u32 m0, s80, 16384
    s_add_u32 s35, s34, 24576
    s_and_b32 s35, s35, 0x3ffff
    buffer_load_dwordx4 v125, s[8:11], s35 offen sc1 lds
    s_add_u32 m0, s80, 20480
    s_add_u32 s35, s34, 28672
    s_and_b32 s35, s35, 0x3ffff
    buffer_load_dwordx4 v125, s[8:11], s35 offen sc1 lds
    s_add_u32 m0, s80, 24576
    s_add_u32 s35, s34, 32768
    s_and_b32 s35, s35, 0x3ffff
    buffer_load_dwordx4 v125, s[8:11], s35 offen sc1 lds
    s_add_u32 m0, s80, 28672
    s_add_u32 s35, s34, 36864
    s_and_b32 s35, s35, 0x3ffff
    buffer_load_dwordx4 v125, s[8:11], s35 offen sc1 lds
L_c1d2:
    s_branch L_te4
L_tu4:
L_te4:
    s_waitcnt lgkmcnt(1)
    v_mfma_f32_32x32x16_bf16 v[16:31], v[56:59], v[2:5], 0
    ds_read_b128 v[56:59], v116 offset:28672
    v_exp_f32 v32, v32
    v_exp_f32 v33, v33
    v_exp_f32 v34, v34
    v_mfma_f32_32x32x16_bf16 v[72:87], v[68:71], v[52:55], v[72:87]
    ds_read_b128 v[68:71], v116 offset:23552
    v_exp_f32 v35, v35
    v_exp_f32 v36, v36
    v_exp_f32 v37, v37
    v_smfmac_f32_16x16x64_bf16 v[88:91], v[92:95], v[48:55], v0
    v_exp_f32 v38, v38
    v_mfma_f32_32x32x16_bf16 v[16:31], v[60:63], v[6:9], v[16:31]
    ds_read_b128 v[60:63], v116 offset:29696
    v_exp_f32 v39, v39
    v_exp_f32 v40, v40
    v_cvt_pk_bf16_f32 v48, v32, v33
    v_cvt_pk_bf16_f32 v49, v34, v35
    v_cvt_pk_bf16_f32 v50, v36, v37
    v_cvt_pk_bf16_f32 v51, v38, v39
    s_waitcnt lgkmcnt(3)
    v_exp_f32 v41, v41
    v_exp_f32 v42, v42
    v_mfma_f32_32x32x16_bf16 v[72:87], v[64:67], v[48:51], v[72:87]
    ds_read_b128 v[64:67], v116 offset:26624
    v_exp_f32 v43, v43
    v_exp_f32 v44, v44
    v_exp_f32 v45, v45
    v_exp_f32 v46, v46
    v_exp_f32 v47, v47
    v_cvt_pk_bf16_f32 v52, v40, v41
    v_cvt_pk_bf16_f32 v53, v42, v43
    v_cvt_pk_bf16_f32 v54, v44, v45
    v_cvt_pk_bf16_f32 v55, v46, v47
    s_cmp_ge_u32 s3, 4
    s_cbranch_scc1 L_tu5
    s_cmp_lg_u32 s94, 0
    s_cbranch_scc1 L_c1d3
    s_waitcnt vmcnt(0)
    v_cmp_ne_u64 vcc, s[40:41], v[252:253]
    s_mov_b32 s34, 0
    s_cbranch_vccz L_pd3
L_pl3:
    s_sleep 2
    buffer_load_dwordx2 v[252:253], v115, s[8:11], 0 offen sc1
    s_add_u32 s34, s34, 1
    s_waitcnt vmcnt(0)
    v_cmp_ne_u64 vcc, s[40:41], v[252:253]
    s_cmp_ge_u32 s34, 0x40000
    s_cbranch_scc1 L_pd3
    s_cbranch_vccnz L_pl3
L_pd3:
    s_mov_b32 s94, 1
    s_mov_b32 s34, s78
    s_add_u32 m0, s80, 0
    s_add_u32 s35, s34, 8192
    s_and_b32 s35, s35, 0x3ffff
    buffer_load_dwordx4 v125, s[8:11], s35 offen sc1 lds
    s_add_u32 m0, s80, 4096
    s_add_u32 s35, s34, 12288
    s_and_b32 s35, s35, 0x3ffff
    buffer_load_dwordx4 v125, s[8:11], s35 offen sc1 lds
    s_add_u32 m0, s80, 8192
    s_add_u32 s35, s34, 16384
    s_and_b32 s35, s35, 0x3ffff
    buffer_load_dwordx4 v125, s[8:11], s35 offen sc1 lds
    s_add_u32 m0, s80, 12288
    s_add_u32 s35, s34, 20480
    s_and_b32 s35, s35, 0x3ffff
    buffer_load_dwordx4 v125, s[8:11], s35 offen sc1 lds
    s_add_u32 m0, s80, 16384
    s_add_u32 s35, s34, 24576
    s_and_b32 s35, s35, 0x3ffff
    buffer_load_dwordx4 v125, s[8:11], s35 offen sc1 lds
    s_add_u32 m0, s80, 20480
    s_add_u32 s35, s34, 28672
    s_and_b32 s35, s35, 0x3ffff
    buffer_load_dwordx4 v125, s[8:11], s35 offen sc1 lds
    s_add_u32 m0, s80, 24576
    s_add_u32 s35, s34, 32768
    s_and_b32 s35, s35, 0x3ffff
    buffer_load_dwordx4 v125, s[8:11], s35 offen sc1 lds
    s_add_u32 m0, s80, 28672
    s_add_u32 s35, s34, 36864
    s_and_b32 s35, s35, 0x3ffff
    buffer_load_dwordx4 v125, s[8:11], s35 offen sc1 lds
L_c1d3:
    buffer_load_dwordx2 v[252:253], v122, s[8:11], 0 offen sc1
    s_waitcnt vmcnt(7)
    s_branch L_te5
L_tu5:
    s_mov_b32 s35, 0
    s_branch L_ck
L_cr:
    s_sleep 2
    s_lshl_b32 s34, s25, 9
    s_cmp_le_u32 s24, 0
    s_cbranch_scc1 L_le1
    buffer_load_dwordx4 v[196:199], v127, s[8:11], s34 offen sc1
    s_add_u32 s34, s34, 0x4000
    s_cmp_le_u32 s24, 1
    s_cbranch_scc1 L_le1
    buffer_load_dwordx4 v[200:203], v127, s[8:11], s34 offen sc1
    s_add_u32 s34, s34, 0x4000
    s_cmp_le_u32 s24, 2
    s_cbranch_scc1 L_le1
    buffer_load_dwordx4 v[204:207], v127, s[8:11], s34 offen sc1
    s_add_u32 s34, s34, 0x4000
    s_cmp_le_u32 s24, 3
    s_cbranch_scc1 L_le1
    buffer_load_dwordx4 v[208:211], v127, s[8:11], s34 offen sc1
    s_add_u32 s34, s34, 0x4000
    s_cmp_le_u32 s24, 4
    s_cbranch_scc1 L_le1
    buffer_load_dwordx4 v[212:215], v127, s[8:11], s34 offen sc1
    s_add_u32 s34, s34, 0x4000
    s_cmp_le_u32 s24, 5
    s_cbranch_scc1 L_le1
    buffer_load_dwordx4 v[216:219], v127, s[8:11], s34 offen sc1
    s_add_u32 s34, s34, 0x4000
    s_cmp_le_u32 s24, 6
    s_cbranch_scc1 L_le1
    buffer_load_dwordx4 v[220:223], v127, s[8:11], s34 offen sc1
    s_add_u32 s34, s34, 0x4000
L_le1:
    s_add_u32 s35, s35, 1
    s_cmp_ge_u32 s35, 0x40000
    s_cbranch_scc1 L_cd
L_ck:
    v_mov_b32 v224, 0
    v_mov_b32 v225, 0
    s_waitcnt vmcnt(0)
    s_cmp_le_u32 s24, 0
    s_cbranch_scc1 L_cd
    v_cmp_ne_u64 vcc, s[40:41], v[198:199]
    s_cbranch_vccnz L_cr
    v_pk_fma_f32 v[244:245], v[236:237], v[224:225], v[196:197] op_sel_hi:[0,1,1]
    v_pk_fma_f32 v[224:225], v[236:237], v[224:225], v[244:245] op_sel:[1,1,0] op_sel_hi:[1,0,1] neg_lo:[1,0,0]
    s_cmp_le_u32 s24, 1
    s_cbranch_scc1 L_cd
    v_cmp_ne_u64 vcc, s[40:41], v[202:203]
    s_cbranch_vccnz L_cr
    v_pk_fma_f32 v[244:245], v[236:237], v[224:225], v[200:201] op_sel_hi:[0,1,1]
    v_pk_fma_f32 v[224:225], v[236:237], v[224:225], v[244:245] op_sel:[1,1,0] op_sel_hi:[1,0,1] neg_lo:[1,0,0]
    s_cmp_le_u32 s24, 2
    s_cbranch_scc1 L_cd
    v_cmp_ne_u64 vcc, s[40:41], v[206:207]
    s_cbranch_vccnz L_cr
    v_pk_fma_f32 v[244:245], v[236:237], v[224:225], v[204:205] op_sel_hi:[0,1,1]
    v_pk_fma_f32 v[224:225], v[236:237], v[224:225], v[244:245] op_sel:[1,1,0] op_sel_hi:[1,0,1] neg_lo:[1,0,0]
    s_cmp_le_u32 s24, 3
    s_cbranch_scc1 L_cd
    v_cmp_ne_u64 vcc, s[40:41], v[210:211]
    s_cbranch_vccnz L_cr
    v_pk_fma_f32 v[244:245], v[236:237], v[224:225], v[208:209] op_sel_hi:[0,1,1]
    v_pk_fma_f32 v[224:225], v[236:237], v[224:225], v[244:245] op_sel:[1,1,0] op_sel_hi:[1,0,1] neg_lo:[1,0,0]
    s_cmp_le_u32 s24, 4
    s_cbranch_scc1 L_cd
    v_cmp_ne_u64 vcc, s[40:41], v[214:215]
    s_cbranch_vccnz L_cr
    v_pk_fma_f32 v[244:245], v[236:237], v[224:225], v[212:213] op_sel_hi:[0,1,1]
    v_pk_fma_f32 v[224:225], v[236:237], v[224:225], v[244:245] op_sel:[1,1,0] op_sel_hi:[1,0,1] neg_lo:[1,0,0]
    s_cmp_le_u32 s24, 5
    s_cbranch_scc1 L_cd
    v_cmp_ne_u64 vcc, s[40:41], v[218:219]
    s_cbranch_vccnz L_cr
    v_pk_fma_f32 v[244:245], v[236:237], v[224:225], v[216:217] op_sel_hi:[0,1,1]
    v_pk_fma_f32 v[224:225], v[236:237], v[224:225], v[244:245] op_sel:[1,1,0] op_sel_hi:[1,0,1] neg_lo:[1,0,0]
    s_cmp_le_u32 s24, 6
    s_cbranch_scc1 L_cd
    v_cmp_ne_u64 vcc, s[40:41], v[222:223]
    s_cbranch_vccnz L_cr
    v_pk_fma_f32 v[244:245], v[236:237], v[224:225], v[220:221] op_sel_hi:[0,1,1]
    v_pk_fma_f32 v[224:225], v[236:237], v[224:225], v[244:245] op_sel:[1,1,0] op_sel_hi:[1,0,1] neg_lo:[1,0,0]
L_cd:
    v_pk_fma_f32 v[244:245], v[238:239], v[224:225], v[242:243] op_sel_hi:[0,1,1]
    v_pk_fma_f32 v[224:225], v[238:239], v[224:225], v[244:245] op_sel:[1,1,0] op_sel_hi:[1,0,1] neg_lo:[1,0,0]
    v_pk_fma_f32 v[244:245], v[232:233], v[224:225], v[240:241] op_sel_hi:[0,1,1]
    v_pk_fma_f32 v[226:227], v[232:233], v[224:225], v[244:245] op_sel:[1,1,0] op_sel_hi:[1,0,1] neg_lo:[1,0,0]
    v_pk_mul_f32 v[244:245], v[230:231], v[224:225] op_sel_hi:[0,1]
    v_pk_fma_f32 v[224:225], v[230:231], v[224:225], v[244:245] op_sel:[1,1,0] op_sel_hi:[1,0,1] neg_lo:[1,0,0]
    v_pk_mul_f32 v[246:247], v[230:231], v[226:227] op_sel_hi:[0,1]
    v_pk_fma_f32 v[226:227], v[230:231], v[226:227], v[246:247] op_sel:[1,1,0] op_sel_hi:[1,0,1] neg_lo:[1,0,0]
    v_pk_mov_b32 v[210:211], v[224:225], v[226:227] op_sel:[0,0]
    v_pk_mov_b32 v[212:213], v[224:225], v[226:227] op_sel:[1,1]
    v_xor_b32 v209, 64, v248
    v_xor_b32 v224, 0x80, v248
    v_xor_b32 v225, 0xc0, v248
    s_lshl_b32 s34, s24, 3
    s_lshl_b32 s35, s37, 1
    s_add_u32 s34, s34, s35
    s_lshl_b32 s34, s34, 17
    s_lshl_b32 s35, s25, 11
    s_add_u32 s34, s34, s35
    s_add_u32 s34, s34, 16777216
    v_pk_fma_f32 v[244:245], v[228:229], v[210:211], v[128:129] op_sel_hi:[0,1,1]
    v_pk_fma_f32 v[246:247], v[228:229], v[212:213], v[160:161] op_sel_hi:[0,1,1]
    v_pk_fma_f32 v[128:129], v[228:229], v[212:213], v[244:245] op_sel:[1,0,0] neg_lo:[1,0,0] neg_hi:[1,0,0]
    v_pk_fma_f32 v[160:161], v[228:229], v[210:211], v[246:247] op_sel:[1,0,0]
    v_pk_fma_f32 v[244:245], v[228:229], v[128:129], v[130:131] op_sel_hi:[0,1,1]
    v_pk_fma_f32 v[246:247], v[228:229], v[160:161], v[162:163] op_sel_hi:[0,1,1]
    v_pk_fma_f32 v[130:131], v[228:229], v[160:161], v[244:245] op_sel:[1,0,0] neg_lo:[1,0,0] neg_hi:[1,0,0]
    v_pk_fma_f32 v[162:163], v[228:229], v[128:129], v[246:247] op_sel:[1,0,0]
    v_pk_fma_f32 v[244:245], v[228:229], v[130:131], v[132:133] op_sel_hi:[0,1,1]
    v_pk_fma_f32 v[246:247], v[228:229], v[162:163], v[164:165] op_sel_hi:[0,1,1]
    v_pk_fma_f32 v[132:133], v[228:229], v[162:163], v[244:245] op_sel:[1,0,0] neg_lo:[1,0,0] neg_hi:[1,0,0]
    v_pk_fma_f32 v[164:165], v[228:229], v[130:131], v[246:247] op_sel:[1,0,0]
    v_cvt_pk_bf16_f32 v96, v128, v130
    v_cvt_pk_bf16_f32 v100, v129, v131
    v_pk_fma_f32 v[244:245], v[228:229], v[132:133], v[134:135] op_sel_hi:[0,1,1]
    v_pk_fma_f32 v[246:247], v[228:229], v[164:165], v[166:167] op_sel_hi:[0,1,1]
    v_pk_fma_f32 v[134:135], v[228:229], v[164:165], v[244:245] op_sel:[1,0,0] neg_lo:[1,0,0] neg_hi:[1,0,0]
    v_pk_fma_f32 v[166:167], v[228:229], v[132:133], v[246:247] op_sel:[1,0,0]
    v_cvt_pk_bf16_f32 v192, -v160, -v162
    v_cvt_pk_bf16_f32 v196, -v161, -v163
    v_pk_fma_f32 v[244:245], v[228:229], v[134:135], v[136:137] op_sel_hi:[0,1,1]
    v_pk_fma_f32 v[246:247], v[228:229], v[166:167], v[168:169] op_sel_hi:[0,1,1]
    v_pk_fma_f32 v[136:137], v[228:229], v[166:167], v[244:245] op_sel:[1,0,0] neg_lo:[1,0,0] neg_hi:[1,0,0]
    v_pk_fma_f32 v[168:169], v[228:229], v[134:135], v[246:247] op_sel:[1,0,0]
    v_cvt_pk_bf16_f32 v97, v132, v134
    v_cvt_pk_bf16_f32 v101, v133, v135
    v_pk_fma_f32 v[244:245], v[228:229], v[136:137], v[138:139] op_sel_hi:[0,1,1]
    v_pk_fma_f32 v[246:247], v[228:229], v[168:169], v[170:171] op_sel_hi:[0,1,1]
    v_pk_fma_f32 v[138:139], v[228:229], v[168:169], v[244:245] op_sel:[1,0,0] neg_lo:[1,0,0] neg_hi:[1,0,0]
    v_pk_fma_f32 v[170:171], v[228:229], v[136:137], v[246:247] op_sel:[1,0,0]
    v_cvt_pk_bf16_f32 v193, -v164, -v166
    v_cvt_pk_bf16_f32 v197, -v165, -v167
    v_pk_fma_f32 v[244:245], v[228:229], v[138:139], v[140:141] op_sel_hi:[0,1,1]
    v_pk_fma_f32 v[246:247], v[228:229], v[170:171], v[172:173] op_sel_hi:[0,1,1]
    v_pk_fma_f32 v[140:141], v[228:229], v[170:171], v[244:245] op_sel:[1,0,0] neg_lo:[1,0,0] neg_hi:[1,0,0]
    v_pk_fma_f32 v[172:173], v[228:229], v[138:139], v[246:247] op_sel:[1,0,0]
    v_cvt_pk_bf16_f32 v98, v136, v138
    v_cvt_pk_bf16_f32 v102, v137, v139
    v_pk_fma_f32 v[244:245], v[228:229], v[140:141], v[142:143] op_sel_hi:[0,1,1]
    v_pk_fma_f32 v[246:247], v[228:229], v[172:173], v[174:175] op_sel_hi:[0,1,1]
    v_pk_fma_f32 v[142:143], v[228:229], v[172:173], v[244:245] op_sel:[1,0,0] neg_lo:[1,0,0] neg_hi:[1,0,0]
    v_pk_fma_f32 v[174:175], v[228:229], v[140:141], v[246:247] op_sel:[1,0,0]
    v_cvt_pk_bf16_f32 v194, -v168, -v170
    v_cvt_pk_bf16_f32 v198, -v169, -v171
    v_pk_fma_f32 v[244:245], v[228:229], v[142:143], v[144:145] op_sel_hi:[0,1,1]
    v_pk_fma_f32 v[246:247], v[228:229], v[174:175], v[176:177] op_sel_hi:[0,1,1]
    v_pk_fma_f32 v[144:145], v[228:229], v[174:175], v[244:245] op_sel:[1,0,0] neg_lo:[1,0,0] neg_hi:[1,0,0]
    v_pk_fma_f32 v[176:177], v[228:229], v[142:143], v[246:247] op_sel:[1,0,0]
    v_cvt_pk_bf16_f32 v99, v140, v142
    v_cvt_pk_bf16_f32 v103, v141, v143
    v_pk_fma_f32 v[244:245], v[228:229], v[144:145], v[146:147] op_sel_hi:[0,1,1]
    v_pk_fma_f32 v[246:247], v[228:229], v[176:177], v[178:179] op_sel_hi:[0,1,1]
    v_pk_fma_f32 v[146:147], v[228:229], v[176:177], v[244:245] op_sel:[1,0,0] neg_lo:[1,0,0] neg_hi:[1,0,0]
    v_pk_fma_f32 v[178:179], v[228:229], v[144:145], v[246:247] op_sel:[1,0,0]
    v_cvt_pk_bf16_f32 v195, -v172, -v174
    v_cvt_pk_bf16_f32 v199, -v173, -v175
    ds_write_b128 v248, v[96:99] offset:0
    ds_write_b128 v224, v[100:103] offset:1024
    ds_write_b128 v248, v[192:195] offset:2048
    ds_write_b128 v224, v[196:199] offset:3072
    v_pk_fma_f32 v[244:245], v[228:229], v[146:147], v[148:149] op_sel_hi:[0,1,1]
    v_pk_fma_f32 v[246:247], v[228:229], v[178:179], v[180:181] op_sel_hi:[0,1,1]
    v_pk_fma_f32 v[148:149], v[228:229], v[178:179], v[244:245] op_sel:[1,0,0] neg_lo:[1,0,0] neg_hi:[1,0,0]
    v_pk_fma_f32 v[180:181], v[228:229], v[146:147], v[246:247] op_sel:[1,0,0]
    v_cvt_pk_bf16_f32 v200, v144, v146
    v_cvt_pk_bf16_f32 v204, v145, v147
    v_pk_fma_f32 v[244:245], v[228:229], v[148:149], v[150:151] op_sel_hi:[0,1,1]
    v_pk_fma_f32 v[246:247], v[228:229], v[180:181], v[182:183] op_sel_hi:[0,1,1]
    v_pk_fma_f32 v[150:151], v[228:229], v[180:181], v[244:245] op_sel:[1,0,0] neg_lo:[1,0,0] neg_hi:[1,0,0]
    v_pk_fma_f32 v[182:183], v[228:229], v[148:149], v[246:247] op_sel:[1,0,0]
    v_cvt_pk_bf16_f32 v216, -v176, -v178
    v_cvt_pk_bf16_f32 v220, -v177, -v179
    v_pk_fma_f32 v[244:245], v[228:229], v[150:151], v[152:153] op_sel_hi:[0,1,1]
    v_pk_fma_f32 v[246:247], v[228:229], v[182:183], v[184:185] op_sel_hi:[0,1,1]
    v_pk_fma_f32 v[152:153], v[228:229], v[182:183], v[244:245] op_sel:[1,0,0] neg_lo:[1,0,0] neg_hi:[1,0,0]
    v_pk_fma_f32 v[184:185], v[228:229], v[150:151], v[246:247] op_sel:[1,0,0]
    v_cvt_pk_bf16_f32 v201, v148, v150
    v_cvt_pk_bf16_f32 v205, v149, v151
    v_pk_fma_f32 v[244:245], v[228:229], v[152:153], v[154:155] op_sel_hi:[0,1,1]
    v_pk_fma_f32 v[246:247], v[228:229], v[184:185], v[186:187] op_sel_hi:[0,1,1]
    v_pk_fma_f32 v[154:155], v[228:229], v[184:185], v[244:245] op_sel:[1,0,0] neg_lo:[1,0,0] neg_hi:[1,0,0]
    v_pk_fma_f32 v[186:187], v[228:229], v[152:153], v[246:247] op_sel:[1,0,0]
    v_cvt_pk_bf16_f32 v217, -v180, -v182
    v_cvt_pk_bf16_f32 v221, -v181, -v183
    v_pk_fma_f32 v[244:245], v[228:229], v[154:155], v[156:157] op_sel_hi:[0,1,1]
    v_pk_fma_f32 v[246:247], v[228:229], v[186:187], v[188:189] op_sel_hi:[0,1,1]
    v_pk_fma_f32 v[156:157], v[228:229], v[186:187], v[244:245] op_sel:[1,0,0] neg_lo:[1,0,0] neg_hi:[1,0,0]
    v_pk_fma_f32 v[188:189], v[228:229], v[154:155], v[246:247] op_sel:[1,0,0]
    v_cvt_pk_bf16_f32 v202, v152, v154
    v_cvt_pk_bf16_f32 v206, v153, v155
    v_pk_fma_f32 v[244:245], v[228:229], v[156:157], v[158:159] op_sel_hi:[0,1,1]
    v_pk_fma_f32 v[246:247], v[228:229], v[188:189], v[190:191] op_sel_hi:[0,1,1]
    v_pk_fma_f32 v[158:159], v[228:229], v[188:189], v[244:245] op_sel:[1,0,0] neg_lo:[1,0,0] neg_hi:[1,0,0]
    v_pk_fma_f32 v[190:191], v[228:229], v[156:157], v[246:247] op_sel:[1,0,0]
    v_cvt_pk_bf16_f32 v218, -v184, -v186
    v_cvt_pk_bf16_f32 v222, -v185, -v187
    v_cvt_pk_bf16_f32 v203, v156, v158
    v_cvt_pk_bf16_f32 v207, v157, v159
    v_cvt_pk_bf16_f32 v219, -v188, -v190
    v_cvt_pk_bf16_f32 v223, -v189, -v191
    ds_write_b128 v209, v[200:203] offset:512
    ds_write_b128 v225, v[204:207] offset:1536
    ds_write_b128 v209, v[216:219] offset:2560
    ds_write_b128 v225, v[220:223] offset:3584
    s_waitcnt lgkmcnt(0)
    ds_read_b64_tr_b16 v[128:129], v249 offset:0
    ds_read_b64_tr_b16 v[130:131], v250 offset:0
    ds_read_b64_tr_b16 v[132:133], v249 offset:256
    ds_read_b64_tr_b16 v[134:135], v250 offset:256
    ds_read_b64_tr_b16 v[136:137], v249 offset:2048
    ds_read_b64_tr_b16 v[138:139], v250 offset:2048
    ds_read_b64_tr_b16 v[140:141], v249 offset:2304
    ds_read_b64_tr_b16 v[142:143], v250 offset:2304
    ds_read_b64_tr_b16 v[144:145], v249 offset:4096
    ds_read_b64_tr_b16 v[146:147], v250 offset:4096
    ds_read_b64_tr_b16 v[148:149], v249 offset:4352
    ds_read_b64_tr_b16 v[150:151], v250 offset:4352
    s_mov_b32 s96, s34
    s_waitcnt lgkmcnt(8)
    ds_read_b64_tr_b16 v[152:153], v249 offset:6144
    ds_read_b64_tr_b16 v[154:155], v250 offset:6144
    ds_read_b64_tr_b16 v[156:157], v249 offset:6400
    ds_read_b64_tr_b16 v[158:159], v250 offset:6400
    s_waitcnt lgkmcnt(0)
L_te5:
    s_add_u32 s78, s78, 0x8000
    s_barrier
    s_waitcnt lgkmcnt(1)
    v_mfma_f32_32x32x16_bf16 v[32:47], v[56:59], v[2:5], 0
    ds_read_b128 v[56:59], v114 offset:0
    v_exp_f32 v16, v16
    v_exp_f32 v17, v17
    v_exp_f32 v18, v18
    v_mfma_f32_32x32x16_bf16 v[72:87], v[68:71], v[52:55], v[72:87]
    ds_read_b128 v[68:71], v116 offset:27648
    v_exp_f32 v19, v19
    v_exp_f32 v20, v20
    v_exp_f32 v21, v21
    v_smfmac_f32_16x16x64_bf16 v[88:91], v[92:95], v[48:55], v0
    s_cmp_lt_u32 s3, 4
    s_cbranch_scc1 L_sh0
    buffer_store_dwordx4 v[128:131], v114, s[8:11], s96 offen sc1
    buffer_store_dwordx4 v[132:135], v114, s[8:11], s96 offen offset:1024 sc1
    s_add_u32 s96, s96, 0x10000
L_sh0:
    v_exp_f32 v22, v22
    v_mfma_f32_32x32x16_bf16 v[32:47], v[60:63], v[6:9], v[32:47]
    ds_read_b128 v[60:63], v114 offset:1024
    v_exp_f32 v23, v23
    v_exp_f32 v24, v24
    v_cvt_pk_bf16_f32 v48, v16, v17
    v_cvt_pk_bf16_f32 v49, v18, v19
    v_cvt_pk_bf16_f32 v50, v20, v21
    v_cvt_pk_bf16_f32 v51, v22, v23
    s_waitcnt lgkmcnt(3)
    v_exp_f32 v25, v25
    v_exp_f32 v26, v26
    v_mfma_f32_32x32x16_bf16 v[72:87], v[64:67], v[48:51], v[72:87]
    ds_read_b128 v[64:67], v116 offset:30720
    v_exp_f32 v27, v27
    v_exp_f32 v28, v28
    v_exp_f32 v29, v29
    s_cmp_lt_u32 s3, 4
    s_cbranch_scc1 L_sh1
    buffer_store_dwordx4 v[136:139], v114, s[8:11], s96 offen sc1
    buffer_store_dwordx4 v[140:143], v114, s[8:11], s96 offen offset:1024 sc1
    s_add_u32 s96, s96, 0x10000
L_sh1:
    v_exp_f32 v30, v30
    v_exp_f32 v31, v31
    v_cvt_pk_bf16_f32 v52, v24, v25
    v_cvt_pk_bf16_f32 v53, v26, v27
    v_cvt_pk_bf16_f32 v54, v28, v29
    v_cvt_pk_bf16_f32 v55, v30, v31
    s_waitcnt lgkmcnt(1)
    v_mfma_f32_32x32x16_bf16 v[16:31], v[56:59], v[2:5], 0
    ds_read_b128 v[56:59], v114 offset:4096
    v_exp_f32 v32, v32
    v_exp_f32 v33, v33
    v_exp_f32 v34, v34
    v_mfma_f32_32x32x16_bf16 v[72:87], v[68:71], v[52:55], v[72:87]
    ds_read_b128 v[68:71], v116 offset:31744
    v_exp_f32 v35, v35
    v_exp_f32 v36, v36
    v_exp_f32 v37, v37
    v_smfmac_f32_16x16x64_bf16 v[88:91], v[92:95], v[48:55], v0
    s_cmp_lt_u32 s3, 4
    s_cbranch_scc1 L_sh2
    buffer_store_dwordx4 v[144:147], v114, s[8:11], s96 offen sc1
    buffer_store_dwordx4 v[148:151], v114, s[8:11], s96 offen offset:1024 sc1
    s_add_u32 s96, s96, 0x10000
L_sh2:
    v_exp_f32 v38, v38
    v_mfma_f32_32x32x16_bf16 v[16:31], v[60:63], v[6:9], v[16:31]
    ds_read_b128 v[60:63], v114 offset:5120
    v_exp_f32 v39, v39
    v_exp_f32 v40, v40
    v_cvt_pk_bf16_f32 v48, v32, v33
    v_cvt_pk_bf16_f32 v49, v34, v35
    v_cvt_pk_bf16_f32 v50, v36, v37
    v_cvt_pk_bf16_f32 v51, v38, v39
    s_waitcnt lgkmcnt(3)
    v_exp_f32 v41, v41
    v_exp_f32 v42, v42
    v_mfma_f32_32x32x16_bf16 v[72:87], v[64:67], v[48:51], v[72:87]
    ds_read_b128 v[64:67], v114 offset:2048
    v_exp_f32 v43, v43
    v_exp_f32 v44, v44
    v_exp_f32 v45, v45
    s_cmp_lt_u32 s3, 4
    s_cbranch_scc1 L_sh3
    buffer_store_dwordx4 v[152:155], v114, s[8:11], s96 offen sc1
    buffer_store_dwordx4 v[156:159], v114, s[8:11], s96 offen offset:1024 sc1
    s_add_u32 s96, s96, 0x10000
L_sh3:
    v_exp_f32 v46, v46
    v_exp_f32 v47, v47
    v_cvt_pk_bf16_f32 v52, v40, v41
    v_cvt_pk_bf16_f32 v53, v42, v43
    v_cvt_pk_bf16_f32 v54, v44, v45
    v_cvt_pk_bf16_f32 v55, v46, v47
    s_cmp_ge_u32 s3, 4
    s_cbranch_scc1 L_b4
    s_waitcnt vmcnt(5)
L_b4:
    s_waitcnt lgkmcnt(2)
    s_barrier
    s_waitcnt lgkmcnt(1)
    v_mfma_f32_32x32x16_bf16 v[32:47], v[56:59], v[2:5], 0
    ds_read_b128 v[56:59], v114 offset:8192
    v_exp_f32 v16, v16
    v_exp_f32 v17, v17
    v_exp_f32 v18, v18
    v_mfma_f32_32x32x16_bf16 v[72:87], v[68:71], v[52:55], v[72:87]
    ds_read_b128 v[68:71], v114 offset:3072
    v_exp_f32 v19, v19
    v_exp_f32 v20, v20
    v_exp_f32 v21, v21
    v_smfmac_f32_16x16x64_bf16 v[88:91], v[92:95], v[48:55], v0
    v_exp_f32 v22, v22
    v_mfma_f32_32x32x16_bf16 v[32:47], v[60:63], v[6:9], v[32:47]
    ds_read_b128 v[60:63], v114 offset:9216
    v_exp_f32 v23, v23
    v_exp_f32 v24, v24
    v_cvt_pk_bf16_f32 v48, v16, v17
    v_cvt_pk_bf16_f32 v49, v18, v19
    v_cvt_pk_bf16_f32 v50, v20, v21
    v_cvt_pk_bf16_f32 v51, v22, v23
    s_waitcnt lgkmcnt(3)
    v_exp_f32 v25, v25
    v_exp_f32 v26, v26
    v_mfma_f32_32x32x16_bf16 v[72:87], v[64:67], v[48:51], v[72:87]
    ds_read_b128 v[64:67], v114 offset:6144
    v_exp_f32 v27, v27
    v_exp_f32 v28, v28
    v_exp_f32 v29, v29
    v_exp_f32 v30, v30
    v_exp_f32 v31, v31
    v_cvt_pk_bf16_f32 v52, v24, v25
    v_cvt_pk_bf16_f32 v53, v26, v27
    v_cvt_pk_bf16_f32 v54, v28, v29
    v_cvt_pk_bf16_f32 v55, v30, v31
    s_waitcnt lgkmcnt(1)
    v_mfma_f32_32x32x16_bf16 v[16:31], v[56:59], v[2:5], 0
    ds_read_b128 v[56:59], v114 offset:12288
    v_exp_f32 v32, v32
    v_exp_f32 v33, v33
    v_exp_f32 v34, v34
    v_mfma_f32_32x32x16_bf16 v[72:87], v[68:71], v[52:55], v[72:87]
    ds_read_b128 v[68:71], v114 offset:7168
    v_exp_f32 v35, v35
    v_exp_f32 v36, v36
    v_exp_f32 v37, v37
    v_smfmac_f32_16x16x64_bf16 v[88:91], v[92:95], v[48:55], v0
    v_exp_f32 v38, v38
    v_mfma_f32_32x32x16_bf16 v[16:31], v[60:63], v[6:9], v[16:31]
    ds_read_b128 v[60:63], v114 offset:13312
    v_exp_f32 v39, v39
    v_exp_f32 v40, v40
    v_cvt_pk_bf16_f32 v48, v32, v33
    v_cvt_pk_bf16_f32 v49, v34, v35
    v_cvt_pk_bf16_f32 v50, v36, v37
    v_cvt_pk_bf16_f32 v51, v38, v39
    s_waitcnt lgkmcnt(3)
    v_exp_f32 v41, v41
    v_exp_f32 v42, v42
    v_mfma_f32_32x32x16_bf16 v[72:87], v[64:67], v[48:51], v[72:87]
    ds_read_b128 v[64:67], v114 offset:10240
    v_exp_f32 v43, v43
    v_exp_f32 v44, v44
    v_exp_f32 v45, v45
    v_exp_f32 v46, v46
    v_exp_f32 v47, v47
    v_cvt_pk_bf16_f32 v52, v40, v41
    v_cvt_pk_bf16_f32 v53, v42, v43
    v_cvt_pk_bf16_f32 v54, v44, v45
    v_cvt_pk_bf16_f32 v55, v46, v47
    s_cmp_ge_u32 s3, 4
    s_cbranch_scc1 L_pd10
    s_waitcnt vmcnt(0)
    v_cmp_ne_u64 vcc, s[40:41], v[252:253]
    s_mov_b32 s34, 0
    s_cbranch_vccz L_pd10
L_pl10:
    s_sleep 2
    buffer_load_dwordx2 v[252:253], v122, s[8:11], 0 offen sc1
    s_add_u32 s34, s34, 1
    s_waitcnt vmcnt(0)
    v_cmp_ne_u64 vcc, s[40:41], v[252:253]
    s_cmp_ge_u32 s34, 0x40000
    s_cbranch_scc1 L_pd10
    s_cbranch_vccnz L_pl10
L_pd10:
    s_waitcnt vmcnt(63) lgkmcnt(2)
    s_barrier
    s_waitcnt lgkmcnt(1)
    v_mfma_f32_32x32x16_bf16 v[32:47], v[56:59], v[2:5], 0
    ds_read_b128 v[56:59], v114 offset:16384
    v_exp_f32 v16, v16
    v_exp_f32 v17, v17
    v_exp_f32 v18, v18
    v_mfma_f32_32x32x16_bf16 v[72:87], v[68:71], v[52:55], v[72:87]
    ds_read_b128 v[68:71], v114 offset:11264
    v_exp_f32 v19, v19
    v_exp_f32 v20, v20
    v_exp_f32 v21, v21
    v_smfmac_f32_16x16x64_bf16 v[88:91], v[92:95], v[48:55], v0
    s_add_u32 m0, s80, 0
    s_add_u32 s78, s78, 0x2000
    s_and_b32 s78, s78, 0x3ffff
    buffer_load_dwordx4 v125, s[8:11], s78 offen sc1 lds
    v_exp_f32 v22, v22
    v_mfma_f32_32x32x16_bf16 v[32:47], v[60:63], v[6:9], v[32:47]
    ds_read_b128 v[60:63], v114 offset:17408
    v_exp_f32 v23, v23
    v_exp_f32 v24, v24
    v_cvt_pk_bf16_f32 v48, v16, v17
    v_cvt_pk_bf16_f32 v49, v18, v19
    v_cvt_pk_bf16_f32 v50, v20, v21
    v_cvt_pk_bf16_f32 v51, v22, v23
    s_waitcnt lgkmcnt(3)
    v_exp_f32 v25, v25
    v_exp_f32 v26, v26
    v_mfma_f32_32x32x16_bf16 v[72:87], v[64:67], v[48:51], v[72:87]
    ds_read_b128 v[64:67], v114 offset:14336
    v_exp_f32 v27, v27
    v_exp_f32 v28, v28
    v_exp_f32 v29, v29
    v_exp_f32 v30, v30
    v_exp_f32 v31, v31
    v_cvt_pk_bf16_f32 v52, v24, v25
    v_cvt_pk_bf16_f32 v53, v26, v27
    v_cvt_pk_bf16_f32 v54, v28, v29
    v_cvt_pk_bf16_f32 v55, v30, v31
    s_waitcnt lgkmcnt(1)
    v_mfma_f32_32x32x16_bf16 v[16:31], v[56:59], v[2:5], 0
    ds_read_b128 v[56:59], v114 offset:20480
    v_exp_f32 v32, v32
    v_exp_f32 v33, v33
    v_exp_f32 v34, v34
    v_mfma_f32_32x32x16_bf16 v[72:87], v[68:71], v[52:55], v[72:87]
    ds_read_b128 v[68:71], v114 offset:15360
    v_exp_f32 v35, v35
    v_exp_f32 v36, v36
    v_exp_f32 v37, v37
    v_smfmac_f32_16x16x64_bf16 v[88:91], v[92:95], v[48:55], v0
    v_exp_f32 v38, v38
    v_mfma_f32_32x32x16_bf16 v[16:31], v[60:63], v[6:9], v[16:31]
    ds_read_b128 v[60:63], v114 offset:21504
    v_exp_f32 v39, v39
    v_exp_f32 v40, v40
    v_cvt_pk_bf16_f32 v48, v32, v33
    v_cvt_pk_bf16_f32 v49, v34, v35
    v_cvt_pk_bf16_f32 v50, v36, v37
    v_cvt_pk_bf16_f32 v51, v38, v39
    s_waitcnt lgkmcnt(3)
    v_exp_f32 v41, v41
    v_exp_f32 v42, v42
    v_mfma_f32_32x32x16_bf16 v[72:87], v[64:67], v[48:51], v[72:87]
    ds_read_b128 v[64:67], v114 offset:18432
    v_exp_f32 v43, v43
    v_exp_f32 v44, v44
    v_exp_f32 v45, v45
    v_exp_f32 v46, v46
    v_exp_f32 v47, v47
    v_cvt_pk_bf16_f32 v52, v40, v41
    v_cvt_pk_bf16_f32 v53, v42, v43
    v_cvt_pk_bf16_f32 v54, v44, v45
    v_cvt_pk_bf16_f32 v55, v46, v47
    s_waitcnt vmcnt(1) lgkmcnt(2)
    s_cmp_lt_u32 s3, 4
    s_cbranch_scc1 L_b5
    s_lshl3_add_u32 s34, s76, s3
    s_lshl_b32 s34, s34, 7
    s_add_u32 s34, s34, 50593792
    v_mov_b32 v13, s34
    v_mov_b32 v14, s40
    v_mov_b32 v15, s41
    s_mov_b64 exec, 1
    buffer_store_dwordx2 v[14:15], v13, s[8:11], 0 offen sc1
    s_mov_b64 exec, -1
L_b5:
    s_barrier
    s_waitcnt lgkmcnt(1)
    v_mfma_f32_32x32x16_bf16 v[32:47], v[56:59], v[2:5], 0
    ds_read_b128 v[56:59], v114 offset:24576
    v_exp_f32 v16, v16
    v_exp_f32 v17, v17
    v_exp_f32 v18, v18
    v_mfma_f32_32x32x16_bf16 v[72:87], v[68:71], v[52:55], v[72:87]
    ds_read_b128 v[68:71], v114 offset:19456
    v_exp_f32 v19, v19
    v_exp_f32 v20, v20
    v_exp_f32 v21, v21
    v_smfmac_f32_16x16x64_bf16 v[88:91], v[92:95], v[48:55], v0
    s_add_u32 m0, s80, 8192
    s_add_u32 s78, s78, 0x2000
    s_and_b32 s78, s78, 0x3ffff
    buffer_load_dwordx4 v125, s[8:11], s78 offen sc1 lds
    v_exp_f32 v22, v22
    v_mfma_f32_32x32x16_bf16 v[32:47], v[60:63], v[6:9], v[32:47]
    ds_read_b128 v[60:63], v114 offset:25600
    v_exp_f32 v23, v23
    v_exp_f32 v24, v24
    v_cvt_pk_bf16_f32 v48, v16, v17
    v_cvt_pk_bf16_f32 v49, v18, v19
    v_cvt_pk_bf16_f32 v50, v20, v21
    v_cvt_pk_bf16_f32 v51, v22, v23
    s_waitcnt lgkmcnt(3)
    v_exp_f32 v25, v25
    v_exp_f32 v26, v26
    v_mfma_f32_32x32x16_bf16 v[72:87], v[64:67], v[48:51], v[72:87]
    ds_read_b128 v[64:67], v114 offset:22528
    v_exp_f32 v27, v27
    v_exp_f32 v28, v28
    v_exp_f32 v29, v29
    s_add_u32 m0, s80, 65536
    s_nop 0
    buffer_load_dwordx4 v12, s[16:19], s82 offen lds
    s_add_u32 s82, s82, 0x20000
    s_and_b32 s82, s82, 0x1fffff
    v_exp_f32 v30, v30
    v_exp_f32 v31, v31
    v_cvt_pk_bf16_f32 v52, v24, v25
    v_cvt_pk_bf16_f32 v53, v26, v27
    v_cvt_pk_bf16_f32 v54, v28, v29
    v_cvt_pk_bf16_f32 v55, v30, v31
    s_waitcnt lgkmcnt(1)
    v_mfma_f32_32x32x16_bf16 v[16:31], v[56:59], v[2:5], 0
    ds_read_b128 v[56:59], v114 offset:28672
    v_exp_f32 v32, v32
    v_exp_f32 v33, v33
    v_exp_f32 v34, v34
    v_mfma_f32_32x32x16_bf16 v[72:87], v[68:71], v[52:55], v[72:87]
    ds_read_b128 v[68:71], v114 offset:23552
    v_exp_f32 v35, v35
    v_exp_f32 v36, v36
    v_exp_f32 v37, v37
    v_smfmac_f32_16x16x64_bf16 v[88:91], v[92:95], v[48:55], v0
    s_add_u32 m0, s80, 73728
    s_nop 0
    buffer_load_dwordx4 v12, s[16:19], s82 offen lds
    s_add_u32 s82, s82, 0x20000
    s_and_b32 s82, s82, 0x1fffff
    v_exp_f32 v38, v38
    v_mfma_f32_32x32x16_bf16 v[16:31], v[60:63], v[6:9], v[16:31]
    ds_read_b128 v[60:63], v114 offset:29696
    v_exp_f32 v39, v39
    v_exp_f32 v40, v40
    v_cvt_pk_bf16_f32 v48, v32, v33
    v_cvt_pk_bf16_f32 v49, v34, v35
    v_cvt_pk_bf16_f32 v50, v36, v37
    v_cvt_pk_bf16_f32 v51, v38, v39
    s_waitcnt lgkmcnt(3)
    v_exp_f32 v41, v41
    v_exp_f32 v42, v42
    v_mfma_f32_32x32x16_bf16 v[72:87], v[64:67], v[48:51], v[72:87]
    ds_read_b128 v[64:67], v114 offset:26624
    v_exp_f32 v43, v43
    v_exp_f32 v44, v44
    v_exp_f32 v45, v45
    v_exp_f32 v46, v46
    v_exp_f32 v47, v47
    v_cvt_pk_bf16_f32 v52, v40, v41
    v_cvt_pk_bf16_f32 v53, v42, v43
    v_cvt_pk_bf16_f32 v54, v44, v45
    v_cvt_pk_bf16_f32 v55, v46, v47
    s_waitcnt vmcnt(3) lgkmcnt(2)
    s_barrier
    s_waitcnt lgkmcnt(1)
    v_mfma_f32_32x32x16_bf16 v[32:47], v[56:59], v[2:5], 0
    ds_read_b128 v[56:59], v114 offset:0
    v_exp_f32 v16, v16
    v_exp_f32 v17, v17
    v_exp_f32 v18, v18
    v_mfma_f32_32x32x16_bf16 v[72:87], v[68:71], v[52:55], v[72:87]
    ds_read_b128 v[68:71], v114 offset:27648
    v_exp_f32 v19, v19
    v_exp_f32 v20, v20
    v_exp_f32 v21, v21
    v_smfmac_f32_16x16x64_bf16 v[88:91], v[92:95], v[48:55], v0
    s_add_u32 m0, s80, 16384
    s_add_u32 s78, s78, 0x2000
    s_and_b32 s78, s78, 0x3ffff
    buffer_load_dwordx4 v125, s[8:11], s78 offen sc1 lds
    v_exp_f32 v22, v22
    v_mfma_f32_32x32x16_bf16 v[32:47], v[60:63], v[6:9], v[32:47]
    ds_read_b128 v[60:63], v114 offset:1024
    v_exp_f32 v23, v23
    v_exp_f32 v24, v24
    v_cvt_pk_bf16_f32 v48, v16, v17
    v_cvt_pk_bf16_f32 v49, v18, v19
    v_cvt_pk_bf16_f32 v50, v20, v21
    v_cvt_pk_bf16_f32 v51, v22, v23
    s_waitcnt lgkmcnt(3)
    v_exp_f32 v25, v25
    v_exp_f32 v26, v26
    v_mfma_f32_32x32x16_bf16 v[72:87], v[64:67], v[48:51], v[72:87]
    ds_read_b128 v[64:67], v114 offset:30720
    v_exp_f32 v27, v27
    v_exp_f32 v28, v28
    v_exp_f32 v29, v29
    s_add_u32 m0, s80, 81920
    s_nop 0
    buffer_load_dwordx4 v12, s[16:19], s82 offen lds
    s_add_u32 s82, s82, 0x20000
    s_and_b32 s82, s82, 0x1fffff
    v_exp_f32 v30, v30
    v_exp_f32 v31, v31
    v_cvt_pk_bf16_f32 v52, v24, v25
    v_cvt_pk_bf16_f32 v53, v26, v27
    v_cvt_pk_bf16_f32 v54, v28, v29
    v_cvt_pk_bf16_f32 v55, v30, v31
    s_waitcnt lgkmcnt(1)
    v_mfma_f32_32x32x16_bf16 v[16:31], v[56:59], v[2:5], 0
    ds_read_b128 v[56:59], v114 offset:4096
    v_exp_f32 v32, v32
    v_exp_f32 v33, v33
    v_exp_f32 v34, v34
    v_mfma_f32_32x32x16_bf16 v[72:87], v[68:71], v[52:55], v[72:87]
    ds_read_b128 v[68:71], v114 offset:31744
    v_exp_f32 v35, v35
    v_exp_f32 v36, v36
    v_exp_f32 v37, v37
    v_smfmac_f32_16x16x64_bf16 v[88:91], v[92:95], v[48:55], v0
    s_add_u32 m0, s80, 90112
    s_nop 0
    buffer_load_dwordx4 v12, s[16:19], s82 offen lds
    s_add_u32 s82, s82, 0x20000
    s_and_b32 s82, s82, 0x1fffff
    v_exp_f32 v38, v38
    v_mfma_f32_32x32x16_bf16 v[16:31], v[60:63], v[6:9], v[16:31]
    ds_read_b128 v[60:63], v114 offset:5120
    v_exp_f32 v39, v39
    v_exp_f32 v40, v40
    v_cvt_pk_bf16_f32 v48, v32, v33
    v_cvt_pk_bf16_f32 v49, v34, v35
    v_cvt_pk_bf16_f32 v50, v36, v37
    v_cvt_pk_bf16_f32 v51, v38, v39
    s_waitcnt lgkmcnt(3)
    v_exp_f32 v41, v41
    v_exp_f32 v42, v42
    v_mfma_f32_32x32x16_bf16 v[72:87], v[64:67], v[48:51], v[72:87]
    ds_read_b128 v[64:67], v114 offset:2048
    v_exp_f32 v43, v43
    v_exp_f32 v44, v44
    v_exp_f32 v45, v45
    v_exp_f32 v46, v46
    v_exp_f32 v47, v47
    v_cvt_pk_bf16_f32 v52, v40, v41
    v_cvt_pk_bf16_f32 v53, v42, v43
    v_cvt_pk_bf16_f32 v54, v44, v45
    v_cvt_pk_bf16_f32 v55, v46, v47
    s_waitcnt vmcnt(3) lgkmcnt(2)
    s_barrier
    buffer_load_dwordx2 v[252:253], v123, s[8:11], 0 offen sc1
    s_waitcnt lgkmcnt(1)
    v_mfma_f32_32x32x16_bf16 v[32:47], v[56:59], v[2:5], 0
    ds_read_b128 v[56:59], v114 offset:8192
    v_exp_f32 v16, v16
    v_exp_f32 v17, v17
    v_exp_f32 v18, v18
    v_mfma_f32_32x32x16_bf16 v[72:87], v[68:71], v[52:55], v[72:87]
    ds_read_b128 v[68:71], v114 offset:3072
    v_exp_f32 v19, v19
    v_exp_f32 v20, v20
    v_exp_f32 v21, v21
    v_smfmac_f32_16x16x64_bf16 v[88:91], v[92:95], v[48:55], v0
    s_add_u32 m0, s80, 24576
    s_add_u32 s78, s78, 0x2000
    s_and_b32 s78, s78, 0x3ffff
    buffer_load_dwordx4 v125, s[8:11], s78 offen sc1 lds
    v_exp_f32 v22, v22
    v_mfma_f32_32x32x16_bf16 v[32:47], v[60:63], v[6:9], v[32:47]
    ds_read_b128 v[60:63], v114 offset:9216
    v_exp_f32 v23, v23
    v_exp_f32 v24, v24
    v_cvt_pk_bf16_f32 v48, v16, v17
    v_cvt_pk_bf16_f32 v49, v18, v19
    v_cvt_pk_bf16_f32 v50, v20, v21
    v_cvt_pk_bf16_f32 v51, v22, v23
    s_waitcnt lgkmcnt(3)
    v_exp_f32 v25, v25
    v_exp_f32 v26, v26
    v_mfma_f32_32x32x16_bf16 v[72:87], v[64:67], v[48:51], v[72:87]
    ds_read_b128 v[64:67], v114 offset:6144
    v_exp_f32 v27, v27
    v_exp_f32 v28, v28
    v_exp_f32 v29, v29
    s_add_u32 m0, s80, 98304
    s_nop 0
    buffer_load_dwordx4 v12, s[16:19], s82 offen lds
    s_add_u32 s82, s82, 0x20000
    s_and_b32 s82, s82, 0x1fffff
    v_exp_f32 v30, v30
    v_exp_f32 v31, v31
    v_cvt_pk_bf16_f32 v52, v24, v25
    v_cvt_pk_bf16_f32 v53, v26, v27
    v_cvt_pk_bf16_f32 v54, v28, v29
    v_cvt_pk_bf16_f32 v55, v30, v31
    s_waitcnt lgkmcnt(1)
    v_mfma_f32_32x32x16_bf16 v[16:31], v[56:59], v[2:5], 0
    ds_read_b128 v[56:59], v114 offset:12288
    v_exp_f32 v32, v32
    v_exp_f32 v33, v33
    v_exp_f32 v34, v34
    v_mfma_f32_32x32x16_bf16 v[72:87], v[68:71], v[52:55], v[72:87]
    ds_read_b128 v[68:71], v114 offset:7168
    v_exp_f32 v35, v35
    v_exp_f32 v36, v36
    v_exp_f32 v37, v37
    v_smfmac_f32_16x16x64_bf16 v[88:91], v[92:95], v[48:55], v0
    s_add_u32 m0, s80, 106496
    s_nop 0
    buffer_load_dwordx4 v12, s[16:19], s82 offen lds
    s_add_u32 s82, s82, 0x20000
    s_and_b32 s82, s82, 0x1fffff
    v_exp_f32 v38, v38
    v_mfma_f32_32x32x16_bf16 v[16:31], v[60:63], v[6:9], v[16:31]
    ds_read_b128 v[60:63], v114 offset:13312
    v_exp_f32 v39, v39
    v_exp_f32 v40, v40
    v_cvt_pk_bf16_f32 v48, v32, v33
    v_cvt_pk_bf16_f32 v49, v34, v35
    v_cvt_pk_bf16_f32 v50, v36, v37
    v_cvt_pk_bf16_f32 v51, v38, v39
    s_waitcnt lgkmcnt(3)
    v_exp_f32 v41, v41
    v_exp_f32 v42, v42
    v_mfma_f32_32x32x16_bf16 v[72:87], v[64:67], v[48:51], v[72:87]
    ds_read_b128 v[64:67], v114 offset:10240
    v_exp_f32 v43, v43
    v_exp_f32 v44, v44
    v_exp_f32 v45, v45
    v_exp_f32 v46, v46
    v_exp_f32 v47, v47
    v_cvt_pk_bf16_f32 v52, v40, v41
    v_cvt_pk_bf16_f32 v53, v42, v43
    v_cvt_pk_bf16_f32 v54, v44, v45
    v_cvt_pk_bf16_f32 v55, v46, v47
    s_waitcnt vmcnt(3)
    v_cmp_ne_u64 vcc, s[40:41], v[252:253]
    s_mov_b32 s34, 0
    s_cbranch_vccz L_pd11
L_pl11:
    s_sleep 2
    buffer_load_dwordx2 v[252:253], v123, s[8:11], 0 offen sc1
    s_add_u32 s34, s34, 1
    s_waitcnt vmcnt(0)
    v_cmp_ne_u64 vcc, s[40:41], v[252:253]
    s_cmp_ge_u32 s34, 0x40000
    s_cbranch_scc1 L_pd11
    s_cbranch_vccnz L_pl11
L_pd11:
    s_waitcnt vmcnt(4) lgkmcnt(2)
    s_barrier
    s_waitcnt lgkmcnt(1)
    v_mfma_f32_32x32x16_bf16 v[32:47], v[56:59], v[2:5], 0
    ds_read_b128 v[56:59], v114 offset:16384
    v_exp_f32 v16, v16
    v_exp_f32 v17, v17
    v_exp_f32 v18, v18
    v_mfma_f32_32x32x16_bf16 v[72:87], v[68:71], v[52:55], v[72:87]
    ds_read_b128 v[68:71], v114 offset:11264
    v_exp_f32 v19, v19
    v_exp_f32 v20, v20
    v_exp_f32 v21, v21
    v_smfmac_f32_16x16x64_bf16 v[88:91], v[92:95], v[48:55], v0
    s_add_u32 m0, s80, 0
    s_add_u32 s78, s78, 0x2000
    s_and_b32 s78, s78, 0x3ffff
    buffer_load_dwordx4 v125, s[8:11], s78 offen sc1 lds
    v_exp_f32 v22, v22
    v_mfma_f32_32x32x16_bf16 v[32:47], v[60:63], v[6:9], v[32:47]
    ds_read_b128 v[60:63], v114 offset:17408
    v_exp_f32 v23, v23
    v_exp_f32 v24, v24
    buffer_load_dwordx4 v[128:131], v126, s[8:11], s79 offen sc1
    v_cvt_pk_bf16_f32 v48, v16, v17
    v_cvt_pk_bf16_f32 v49, v18, v19
    v_cvt_pk_bf16_f32 v50, v20, v21
    v_cvt_pk_bf16_f32 v51, v22, v23
    s_waitcnt lgkmcnt(3)
    v_exp_f32 v25, v25
    v_exp_f32 v26, v26
    v_mfma_f32_32x32x16_bf16 v[72:87], v[64:67], v[48:51], v[72:87]
    ds_read_b128 v[64:67], v114 offset:14336
    v_exp_f32 v27, v27
    v_exp_f32 v28, v28
    v_exp_f32 v29, v29
    buffer_load_dwordx4 v[132:135], v126, s[8:11], s79 offen offset:256 sc1
    s_add_u32 s79, s79, 0x1000
    s_and_b32 s79, s79, 0x1ffff
    v_exp_f32 v30, v30
    v_exp_f32 v31, v31
    v_cvt_pk_bf16_f32 v52, v24, v25
    v_cvt_pk_bf16_f32 v53, v26, v27
    v_cvt_pk_bf16_f32 v54, v28, v29
    v_cvt_pk_bf16_f32 v55, v30, v31
    s_waitcnt lgkmcnt(1)
    v_mfma_f32_32x32x16_bf16 v[16:31], v[56:59], v[2:5], 0
    ds_read_b128 v[56:59], v114 offset:20480
    v_exp_f32 v32, v32
    v_exp_f32 v33, v33
    v_exp_f32 v34, v34
    v_mfma_f32_32x32x16_bf16 v[72:87], v[68:71], v[52:55], v[72:87]
    ds_read_b128 v[68:71], v114 offset:15360
    v_exp_f32 v35, v35
    v_exp_f32 v36, v36
    v_exp_f32 v37, v37
    v_smfmac_f32_16x16x64_bf16 v[88:91], v[92:95], v[48:55], v0
    s_add_u32 m0, s80, 32768
    s_and_b32 s84, s83, 0x7ff
    s_add_u32 s83, s83, 0x80
    buffer_load_dwordx4 v10, s[12:15], s84 offen lds
    s_bitcmp1_b32 s83, 11
    s_cselect_b32 s12, s56, s54
    s_cselect_b32 s13, s57, s55
    v_exp_f32 v38, v38
    v_mfma_f32_32x32x16_bf16 v[16:31], v[60:63], v[6:9], v[16:31]
    ds_read_b128 v[60:63], v114 offset:21504
    v_exp_f32 v39, v39
    v_exp_f32 v40, v40
    s_add_u32 m0, s80, 114688
    s_nop 0
    buffer_load_dwordx4 v12, s[16:19], s82 offen lds
    s_add_u32 s82, s82, 0x20000
    s_and_b32 s82, s82, 0x1fffff
    v_cvt_pk_bf16_f32 v48, v32, v33
    v_cvt_pk_bf16_f32 v49, v34, v35
    v_cvt_pk_bf16_f32 v50, v36, v37
    v_cvt_pk_bf16_f32 v51, v38, v39
    s_waitcnt lgkmcnt(3)
    v_exp_f32 v41, v41
    v_exp_f32 v42, v42
    v_mfma_f32_32x32x16_bf16 v[72:87], v[64:67], v[48:51], v[72:87]
    ds_read_b128 v[64:67], v114 offset:18432
    v_exp_f32 v43, v43
    v_exp_f32 v44, v44
    v_exp_f32 v45, v45
    s_add_u32 m0, s80, 122880
    s_nop 0
    buffer_load_dwordx4 v12, s[16:19], s82 offen lds
    s_add_u32 s82, s82, 0x20000
    s_and_b32 s82, s82, 0x1fffff
    v_exp_f32 v46, v46
    v_exp_f32 v47, v47
    v_cvt_pk_bf16_f32 v52, v40, v41
    v_cvt_pk_bf16_f32 v53, v42, v43
    v_cvt_pk_bf16_f32 v54, v44, v45
    v_cvt_pk_bf16_f32 v55, v46, v47
    s_waitcnt vmcnt(6) lgkmcnt(2)
    s_barrier
    s_waitcnt lgkmcnt(1)
    v_mfma_f32_32x32x16_bf16 v[32:47], v[56:59], v[2:5], 0
    ds_read_b128 v[56:59], v114 offset:24576
    v_exp_f32 v16, v16
    v_exp_f32 v17, v17
    v_exp_f32 v18, v18
    v_mfma_f32_32x32x16_bf16 v[72:87], v[68:71], v[52:55], v[72:87]
    ds_read_b128 v[68:71], v114 offset:19456
    v_exp_f32 v19, v19
    v_exp_f32 v20, v20
    v_exp_f32 v21, v21
    v_smfmac_f32_16x16x64_bf16 v[88:91], v[92:95], v[48:55], v0
    s_add_u32 m0, s80, 8192
    s_add_u32 s78, s78, 0x2000
    s_and_b32 s78, s78, 0x3ffff
    buffer_load_dwordx4 v125, s[8:11], s78 offen sc1 lds
    v_exp_f32 v22, v22
    v_mfma_f32_32x32x16_bf16 v[32:47], v[60:63], v[6:9], v[32:47]
    ds_read_b128 v[60:63], v114 offset:25600
    v_exp_f32 v23, v23
    v_exp_f32 v24, v24
    buffer_load_dwordx4 v[136:139], v126, s[8:11], s79 offen sc1
    v_cvt_pk_bf16_f32 v48, v16, v17
    v_cvt_pk_bf16_f32 v49, v18, v19
    v_cvt_pk_bf16_f32 v50, v20, v21
    v_cvt_pk_bf16_f32 v51, v22, v23
    s_waitcnt lgkmcnt(3)
    v_exp_f32 v25, v25
    v_exp_f32 v26, v26
    v_mfma_f32_32x32x16_bf16 v[72:87], v[64:67], v[48:51], v[72:87]
    ds_read_b128 v[64:67], v114 offset:22528
    v_exp_f32 v27, v27
    v_exp_f32 v28, v28
    v_exp_f32 v29, v29
    buffer_load_dwordx4 v[140:143], v126, s[8:11], s79 offen offset:256 sc1
    s_add_u32 s79, s79, 0x1000
    s_and_b32 s79, s79, 0x1ffff
    v_exp_f32 v30, v30
    v_exp_f32 v31, v31
    v_cvt_pk_bf16_f32 v52, v24, v25
    v_cvt_pk_bf16_f32 v53, v26, v27
    v_cvt_pk_bf16_f32 v54, v28, v29
    v_cvt_pk_bf16_f32 v55, v30, v31
    s_waitcnt lgkmcnt(1)
    v_mfma_f32_32x32x16_bf16 v[16:31], v[56:59], v[2:5], 0
    ds_read_b128 v[56:59], v114 offset:28672
    v_exp_f32 v32, v32
    v_exp_f32 v33, v33
    v_exp_f32 v34, v34
    v_mfma_f32_32x32x16_bf16 v[72:87], v[68:71], v[52:55], v[72:87]
    ds_read_b128 v[68:71], v114 offset:23552
    v_exp_f32 v35, v35
    v_exp_f32 v36, v36
    v_exp_f32 v37, v37
    v_smfmac_f32_16x16x64_bf16 v[88:91], v[92:95], v[48:55], v0
    s_add_u32 m0, s80, 40960
    s_and_b32 s84, s83, 0x7ff
    s_add_u32 s83, s83, 0x80
    buffer_load_dwordx4 v10, s[12:15], s84 offen lds
    s_bitcmp1_b32 s83, 11
    s_cselect_b32 s12, s56, s54
    s_cselect_b32 s13, s57, s55
    v_exp_f32 v38, v38
    v_mfma_f32_32x32x16_bf16 v[16:31], v[60:63], v[6:9], v[16:31]
    ds_read_b128 v[60:63], v114 offset:29696
    v_exp_f32 v39, v39
    v_exp_f32 v40, v40
    s_add_u32 m0, s80, 131072
    s_nop 0
    buffer_load_dwordx4 v12, s[16:19], s82 offen lds
    s_add_u32 s82, s82, 0x20000
    s_and_b32 s82, s82, 0x1fffff
    v_cvt_pk_bf16_f32 v48, v32, v33
    v_cvt_pk_bf16_f32 v49, v34, v35
    v_cvt_pk_bf16_f32 v50, v36, v37
    v_cvt_pk_bf16_f32 v51, v38, v39
    s_waitcnt lgkmcnt(3)
    v_exp_f32 v41, v41
    v_exp_f32 v42, v42
    v_mfma_f32_32x32x16_bf16 v[72:87], v[64:67], v[48:51], v[72:87]
    ds_read_b128 v[64:67], v114 offset:26624
    v_exp_f32 v43, v43
    v_exp_f32 v44, v44
    v_exp_f32 v45, v45
    s_add_u32 m0, s80, 139264
    s_nop 0
    buffer_load_dwordx4 v12, s[16:19], s82 offen lds
    s_add_u32 s82, s82, 0x20000
    s_and_b32 s82, s82, 0x1fffff
    v_exp_f32 v46, v46
    v_exp_f32 v47, v47
    v_cvt_pk_bf16_f32 v52, v40, v41
    v_cvt_pk_bf16_f32 v53, v42, v43
    v_cvt_pk_bf16_f32 v54, v44, v45
    v_cvt_pk_bf16_f32 v55, v46, v47
    s_waitcnt vmcnt(6) lgkmcnt(2)
    s_barrier
    s_waitcnt lgkmcnt(1)
    v_mfma_f32_32x32x16_bf16 v[32:47], v[56:59], v[2:5], 0
    ds_read_b128 v[56:59], v114 offset:0
    v_exp_f32 v16, v16
    v_exp_f32 v17, v17
    v_exp_f32 v18, v18
    v_mfma_f32_32x32x16_bf16 v[72:87], v[68:71], v[52:55], v[72:87]
    ds_read_b128 v[68:71], v114 offset:27648
    v_exp_f32 v19, v19
    v_exp_f32 v20, v20
    v_exp_f32 v21, v21
    v_smfmac_f32_16x16x64_bf16 v[88:91], v[92:95], v[48:55], v0
    s_add_u32 m0, s80, 16384
    s_add_u32 s78, s78, 0x2000
    s_and_b32 s78, s78, 0x3ffff
    buffer_load_dwordx4 v125, s[8:11], s78 offen sc1 lds
    v_exp_f32 v22, v22
    v_mfma_f32_32x32x16_bf16 v[32:47], v[60:63], v[6:9], v[32:47]
    ds_read_b128 v[60:63], v114 offset:1024
    v_exp_f32 v23, v23
    v_exp_f32 v24, v24
    buffer_load_dwordx4 v[144:147], v126, s[8:11], s79 offen sc1
    v_cvt_pk_bf16_f32 v48, v16, v17
    v_cvt_pk_bf16_f32 v49, v18, v19
    v_cvt_pk_bf16_f32 v50, v20, v21
    v_cvt_pk_bf16_f32 v51, v22, v23
    s_waitcnt lgkmcnt(3)
    v_exp_f32 v25, v25
    v_exp_f32 v26, v26
    v_mfma_f32_32x32x16_bf16 v[72:87], v[64:67], v[48:51], v[72:87]
    ds_read_b128 v[64:67], v114 offset:30720
    v_exp_f32 v27, v27
    v_exp_f32 v28, v28
    v_exp_f32 v29, v29
    buffer_load_dwordx4 v[148:151], v126, s[8:11], s79 offen offset:256 sc1
    s_add_u32 s79, s79, 0x1000
    s_and_b32 s79, s79, 0x1ffff
    v_exp_f32 v30, v30
    v_exp_f32 v31, v31
    v_cvt_pk_bf16_f32 v52, v24, v25
    v_cvt_pk_bf16_f32 v53, v26, v27
    v_cvt_pk_bf16_f32 v54, v28, v29
    v_cvt_pk_bf16_f32 v55, v30, v31
    s_waitcnt lgkmcnt(1)
    v_mfma_f32_32x32x16_bf16 v[16:31], v[56:59], v[2:5], 0
    ds_read_b128 v[56:59], v114 offset:4096
    v_exp_f32 v32, v32
    v_exp_f32 v33, v33
    v_exp_f32 v34, v34
    v_mfma_f32_32x32x16_bf16 v[72:87], v[68:71], v[52:55], v[72:87]
    ds_read_b128 v[68:71], v114 offset:31744
    v_exp_f32 v35, v35
    v_exp_f32 v36, v36
    v_exp_f32 v37, v37
    v_smfmac_f32_16x16x64_bf16 v[88:91], v[92:95], v[48:55], v0
    s_add_u32 m0, s80, 49152
    s_and_b32 s84, s83, 0x7ff
    s_add_u32 s83, s83, 0x80
    buffer_load_dwordx4 v10, s[12:15], s84 offen lds
    s_bitcmp1_b32 s83, 11
    s_cselect_b32 s12, s56, s54
    s_cselect_b32 s13, s57, s55
    v_exp_f32 v38, v38
    v_mfma_f32_32x32x16_bf16 v[16:31], v[60:63], v[6:9], v[16:31]
    ds_read_b128 v[60:63], v114 offset:5120
    v_exp_f32 v39, v39
    v_exp_f32 v40, v40
    s_add_u32 m0, s80, 147456
    s_nop 0
    buffer_load_dwordx4 v12, s[16:19], s82 offen lds
    s_add_u32 s82, s82, 0x20000
    s_and_b32 s82, s82, 0x1fffff
    v_cvt_pk_bf16_f32 v48, v32, v33
    v_cvt_pk_bf16_f32 v49, v34, v35
    v_cvt_pk_bf16_f32 v50, v36, v37
    v_cvt_pk_bf16_f32 v51, v38, v39
    s_waitcnt lgkmcnt(3)
    v_exp_f32 v41, v41
    v_exp_f32 v42, v42
    v_mfma_f32_32x32x16_bf16 v[72:87], v[64:67], v[48:51], v[72:87]
    ds_read_b128 v[64:67], v114 offset:2048
    v_exp_f32 v43, v43
    v_exp_f32 v44, v44
    v_exp_f32 v45, v45
    s_add_u32 m0, s80, 155648
    s_nop 0
    buffer_load_dwordx4 v12, s[16:19], s82 offen lds
    s_add_u32 s82, s82, 0x20000
    s_and_b32 s82, s82, 0x1fffff
    v_exp_f32 v46, v46
    v_exp_f32 v47, v47
    v_cvt_pk_bf16_f32 v52, v40, v41
    v_cvt_pk_bf16_f32 v53, v42, v43
    v_cvt_pk_bf16_f32 v54, v44, v45
    v_cvt_pk_bf16_f32 v55, v46, v47
    v_mov_b32 v192, 0
    v_mov_b32 v193, 0
    v_mov_b32 v194, 0
    v_mov_b32 v195, 0
    v_mov_b32 v196, 0
    v_mov_b32 v197, 0
    v_mov_b32 v198, 0
    v_mov_b32 v199, 0
    v_mov_b32 v200, 0
    v_mov_b32 v201, 0
    v_mov_b32 v202, 0
    v_mov_b32 v203, 0
    v_mov_b32 v204, 0
    v_mov_b32 v205, 0
    v_mov_b32 v206, 0
    v_mov_b32 v207, 0
    v_mov_b32 v208, 0
    v_mov_b32 v209, 0
    v_mov_b32 v210, 0
    v_mov_b32 v211, 0
    v_mov_b32 v212, 0
    v_mov_b32 v213, 0
    v_mov_b32 v214, 0
    v_mov_b32 v215, 0
    v_mov_b32 v216, 0
    v_mov_b32 v217, 0
    v_mov_b32 v218, 0
    v_mov_b32 v219, 0
    v_mov_b32 v220, 0
    v_mov_b32 v221, 0
    v_mov_b32 v222, 0
    v_mov_b32 v223, 0
    ds_read_b128 v[96:99], v117 offset:32768
    ds_read_b128 v[100:103], v117 offset:34816
    s_waitcnt lgkmcnt(0)
    s_mov_b32 s28, 0
    s_waitcnt vmcnt(4)
L_gl:
    s_waitcnt vmcnt(4) lgkmcnt(4)
    s_barrier
    s_waitcnt lgkmcnt(3)
    v_mfma_f32_32x32x16_bf16 v[32:47], v[56:59], v[2:5], 0
    ds_read_b128 v[56:59], v114 offset:8192
    v_exp_f32 v16, v16
    v_exp_f32 v17, v17
    v_exp_f32 v18, v18
    v_mfma_f32_32x32x16_bf16 v[72:87], v[68:71], v[52:55], v[72:87]
    ds_read_b128 v[68:71], v114 offset:3072
    v_exp_f32 v19, v19
    v_exp_f32 v20, v20
    v_exp_f32 v21, v21
    v_smfmac_f32_16x16x64_bf16 v[88:91], v[92:95], v[48:55], v0
    s_add_u32 m0, s80, 24576
    s_add_u32 s78, s78, 0x2000
    s_and_b32 s78, s78, 0x3ffff
    buffer_load_dwordx4 v125, s[8:11], s78 offen sc1 lds
    v_exp_f32 v22, v22
    v_mfma_f32_32x32x16_bf16 v[32:47], v[60:63], v[6:9], v[32:47]
    ds_read_b128 v[60:63], v114 offset:9216
    v_exp_f32 v23, v23
    v_exp_f32 v24, v24
    v_cvt_pk_bf16_f32 v48, v16, v17
    v_cvt_pk_bf16_f32 v49, v18, v19
    v_cvt_pk_bf16_f32 v50, v20, v21
    v_cvt_pk_bf16_f32 v51, v22, v23
    s_waitcnt lgkmcnt(3)
    v_mfma_f32_16x16x32_bf16 v[192:195], v[96:99], v[128:131], v[192:195]
    v_exp_f32 v25, v25
    v_mfma_f32_16x16x32_bf16 v[200:203], v[100:103], v[128:131], v[200:203]
    v_exp_f32 v26, v26
    v_mfma_f32_32x32x16_bf16 v[72:87], v[64:67], v[48:51], v[72:87]
    ds_read_b128 v[64:67], v114 offset:6144
    v_exp_f32 v27, v27
    v_exp_f32 v28, v28
    v_exp_f32 v29, v29
    buffer_load_dwordx4 v[152:155], v126, s[8:11], s79 offen sc1
    v_exp_f32 v30, v30
    v_mfma_f32_16x16x32_bf16 v[196:199], v[96:99], v[132:135], v[196:199]
    ds_read_b128 v[96:99], v117 offset:36864
    v_exp_f32 v31, v31
    v_mfma_f32_16x16x32_bf16 v[204:207], v[100:103], v[132:135], v[204:207]
    ds_read_b128 v[100:103], v117 offset:38912
    v_cvt_pk_bf16_f32 v52, v24, v25
    v_cvt_pk_bf16_f32 v53, v26, v27
    v_cvt_pk_bf16_f32 v54, v28, v29
    v_cvt_pk_bf16_f32 v55, v30, v31
    s_waitcnt lgkmcnt(3)
    v_mfma_f32_32x32x16_bf16 v[16:31], v[56:59], v[2:5], 0
    ds_read_b128 v[56:59], v114 offset:12288
    v_exp_f32 v32, v32
    v_exp_f32 v33, v33
    v_exp_f32 v34, v34
    v_mfma_f32_32x32x16_bf16 v[72:87], v[68:71], v[52:55], v[72:87]
    ds_read_b128 v[68:71], v114 offset:7168
    v_exp_f32 v35, v35
    v_exp_f32 v36, v36
    v_exp_f32 v37, v37
    v_smfmac_f32_16x16x64_bf16 v[88:91], v[92:95], v[48:55], v0
    buffer_load_dwordx4 v[156:159], v126, s[8:11], s79 offen offset:256 sc1
    s_add_u32 s79, s79, 0x1000
    s_and_b32 s79, s79, 0x1ffff
    v_exp_f32 v38, v38
    v_mfma_f32_32x32x16_bf16 v[16:31], v[60:63], v[6:9], v[16:31]
    ds_read_b128 v[60:63], v114 offset:13312
    v_exp_f32 v39, v39
    v_exp_f32 v40, v40
    v_cvt_pk_bf16_f32 v48, v32, v33
    v_cvt_pk_bf16_f32 v49, v34, v35
    v_cvt_pk_bf16_f32 v50, v36, v37
    v_cvt_pk_bf16_f32 v51, v38, v39
    s_waitcnt lgkmcnt(3)
    v_mfma_f32_16x16x32_bf16 v[208:211], v[96:99], v[128:131], v[208:211]
    v_exp_f32 v41, v41
    v_mfma_f32_16x16x32_bf16 v[216:219], v[100:103], v[128:131], v[216:219]
    v_exp_f32 v42, v42
    v_mfma_f32_32x32x16_bf16 v[72:87], v[64:67], v[48:51], v[72:87]
    ds_read_b128 v[64:67], v114 offset:10240
    v_exp_f32 v43, v43
    v_exp_f32 v44, v44
    v_exp_f32 v45, v45
    s_add_u32 m0, s80, 57344
    s_and_b32 s84, s83, 0x7ff
    s_add_u32 s83, s83, 0x80
    buffer_load_dwordx4 v10, s[12:15], s84 offen lds
    s_bitcmp1_b32 s83, 11
    s_cselect_b32 s12, s56, s54
    s_cselect_b32 s13, s57, s55
    v_exp_f32 v46, v46
    v_mfma_f32_16x16x32_bf16 v[212:215], v[96:99], v[132:135], v[212:215]
    ds_read_b128 v[96:99], v117 offset:40960
    v_exp_f32 v47, v47
    v_mfma_f32_16x16x32_bf16 v[220:223], v[100:103], v[132:135], v[220:223]
    ds_read_b128 v[100:103], v117 offset:43008
    v_cvt_pk_bf16_f32 v52, v40, v41
    v_cvt_pk_bf16_f32 v53, v42, v43
    v_cvt_pk_bf16_f32 v54, v44, v45
    v_cvt_pk_bf16_f32 v55, v46, v47
    s_waitcnt vmcnt(4) lgkmcnt(4)
    s_barrier
    s_waitcnt lgkmcnt(3)
    v_mfma_f32_32x32x16_bf16 v[32:47], v[56:59], v[2:5], 0
    ds_read_b128 v[56:59], v114 offset:16384
    v_exp_f32 v16, v16
    v_exp_f32 v17, v17
    v_exp_f32 v18, v18
    v_mfma_f32_32x32x16_bf16 v[72:87], v[68:71], v[52:55], v[72:87]
    ds_read_b128 v[68:71], v114 offset:11264
    v_exp_f32 v19, v19
    v_exp_f32 v20, v20
    v_exp_f32 v21, v21
    v_smfmac_f32_16x16x64_bf16 v[88:91], v[92:95], v[48:55], v0
    s_add_u32 m0, s80, 0
    s_add_u32 s78, s78, 0x2000
    s_and_b32 s78, s78, 0x3ffff
    buffer_load_dwordx4 v125, s[8:11], s78 offen sc1 lds
    v_exp_f32 v22, v22
    v_mfma_f32_32x32x16_bf16 v[32:47], v[60:63], v[6:9], v[32:47]
    ds_read_b128 v[60:63], v114 offset:17408
    v_exp_f32 v23, v23
    v_exp_f32 v24, v24
    v_cvt_pk_bf16_f32 v48, v16, v17
    v_cvt_pk_bf16_f32 v49, v18, v19
    v_cvt_pk_bf16_f32 v50, v20, v21
    v_cvt_pk_bf16_f32 v51, v22, v23
    s_waitcnt lgkmcnt(3)
    v_mfma_f32_16x16x32_bf16 v[192:195], v[96:99], v[136:139], v[192:195]
    v_exp_f32 v25, v25
    v_mfma_f32_16x16x32_bf16 v[200:203], v[100:103], v[136:139], v[200:203]
    v_exp_f32 v26, v26
    v_mfma_f32_32x32x16_bf16 v[72:87], v[64:67], v[48:51], v[72:87]
    ds_read_b128 v[64:67], v114 offset:14336
    v_exp_f32 v27, v27
    v_exp_f32 v28, v28
    v_exp_f32 v29, v29
    buffer_load_dwordx4 v[128:131], v126, s[8:11], s79 offen sc1
    v_exp_f32 v30, v30
    v_mfma_f32_16x16x32_bf16 v[196:199], v[96:99], v[140:143], v[196:199]
    ds_read_b128 v[96:99], v117 offset:45056
    v_exp_f32 v31, v31
    v_mfma_f32_16x16x32_bf16 v[204:207], v[100:103], v[140:143], v[204:207]
    ds_read_b128 v[100:103], v117 offset:47104
    v_cvt_pk_bf16_f32 v52, v24, v25
    v_cvt_pk_bf16_f32 v53, v26, v27
    v_cvt_pk_bf16_f32 v54, v28, v29
    v_cvt_pk_bf16_f32 v55, v30, v31
    s_waitcnt lgkmcnt(3)
    v_mfma_f32_32x32x16_bf16 v[16:31], v[56:59], v[2:5], 0
    ds_read_b128 v[56:59], v114 offset:20480
    v_exp_f32 v32, v32
    v_exp_f32 v33, v33
    v_exp_f32 v34, v34
    v_mfma_f32_32x32x16_bf16 v[72:87], v[68:71], v[52:55], v[72:87]
    ds_read_b128 v[68:71], v114 offset:15360
    v_exp_f32 v35, v35
    v_exp_f32 v36, v36
    v_exp_f32 v37, v37
    v_smfmac_f32_16x16x64_bf16 v[88:91], v[92:95], v[48:55], v0
    buffer_load_dwordx4 v[132:135], v126, s[8:11], s79 offen offset:256 sc1
    s_add_u32 s79, s79, 0x1000
    s_and_b32 s79, s79, 0x1ffff
    v_exp_f32 v38, v38
    v_mfma_f32_32x32x16_bf16 v[16:31], v[60:63], v[6:9], v[16:31]
    ds_read_b128 v[60:63], v114 offset:21504
    v_exp_f32 v39, v39
    v_exp_f32 v40, v40
    v_cvt_pk_bf16_f32 v48, v32, v33
    v_cvt_pk_bf16_f32 v49, v34, v35
    v_cvt_pk_bf16_f32 v50, v36, v37
    v_cvt_pk_bf16_f32 v51, v38, v39
    s_waitcnt lgkmcnt(3)
    v_mfma_f32_16x16x32_bf16 v[208:211], v[96:99], v[136:139], v[208:211]
    v_exp_f32 v41, v41
    v_mfma_f32_16x16x32_bf16 v[216:219], v[100:103], v[136:139], v[216:219]
    v_exp_f32 v42, v42
    v_mfma_f32_32x32x16_bf16 v[72:87], v[64:67], v[48:51], v[72:87]
    ds_read_b128 v[64:67], v114 offset:18432
    v_exp_f32 v43, v43
    v_exp_f32 v44, v44
    v_exp_f32 v45, v45
    s_add_u32 m0, s80, 32768
    s_and_b32 s84, s83, 0x7ff
    s_add_u32 s83, s83, 0x80
    buffer_load_dwordx4 v10, s[12:15], s84 offen lds
    s_bitcmp1_b32 s83, 11
    s_cselect_b32 s12, s56, s54
    s_cselect_b32 s13, s57, s55
    v_exp_f32 v46, v46
    v_mfma_f32_16x16x32_bf16 v[212:215], v[96:99], v[140:143], v[212:215]
    ds_read_b128 v[96:99], v117 offset:49152
    v_exp_f32 v47, v47
    v_mfma_f32_16x16x32_bf16 v[220:223], v[100:103], v[140:143], v[220:223]
    ds_read_b128 v[100:103], v117 offset:51200
    v_cvt_pk_bf16_f32 v52, v40, v41
    v_cvt_pk_bf16_f32 v53, v42, v43
    v_cvt_pk_bf16_f32 v54, v44, v45
    v_cvt_pk_bf16_f32 v55, v46, v47
    s_waitcnt vmcnt(4) lgkmcnt(4)
    s_barrier
    s_waitcnt lgkmcnt(3)
    v_mfma_f32_32x32x16_bf16 v[32:47], v[56:59], v[2:5], 0
    ds_read_b128 v[56:59], v114 offset:24576
    v_exp_f32 v16, v16
    v_exp_f32 v17, v17
    v_exp_f32 v18, v18
    v_mfma_f32_32x32x16_bf16 v[72:87], v[68:71], v[52:55], v[72:87]
    ds_read_b128 v[68:71], v114 offset:19456
    v_exp_f32 v19, v19
    v_exp_f32 v20, v20
    v_exp_f32 v21, v21
    v_smfmac_f32_16x16x64_bf16 v[88:91], v[92:95], v[48:55], v0
    s_add_u32 m0, s80, 8192
    s_add_u32 s78, s78, 0x2000
    s_and_b32 s78, s78, 0x3ffff
    buffer_load_dwordx4 v125, s[8:11], s78 offen sc1 lds
    v_exp_f32 v22, v22
    v_mfma_f32_32x32x16_bf16 v[32:47], v[60:63], v[6:9], v[32:47]
    ds_read_b128 v[60:63], v114 offset:25600
    v_exp_f32 v23, v23
    v_exp_f32 v24, v24
    v_cvt_pk_bf16_f32 v48, v16, v17
    v_cvt_pk_bf16_f32 v49, v18, v19
    v_cvt_pk_bf16_f32 v50, v20, v21
    v_cvt_pk_bf16_f32 v51, v22, v23
    s_waitcnt lgkmcnt(3)
    v_mfma_f32_16x16x32_bf16 v[192:195], v[96:99], v[144:147], v[192:195]
    v_exp_f32 v25, v25
    v_mfma_f32_16x16x32_bf16 v[200:203], v[100:103], v[144:147], v[200:203]
    v_exp_f32 v26, v26
    v_mfma_f32_32x32x16_bf16 v[72:87], v[64:67], v[48:51], v[72:87]
    ds_read_b128 v[64:67], v114 offset:22528
    v_exp_f32 v27, v27
    v_exp_f32 v28, v28
    v_exp_f32 v29, v29
    buffer_load_dwordx4 v[136:139], v126, s[8:11], s79 offen sc1
    v_exp_f32 v30, v30
    v_mfma_f32_16x16x32_bf16 v[196:199], v[96:99], v[148:151], v[196:199]
    ds_read_b128 v[96:99], v117 offset:53248
    v_exp_f32 v31, v31
    v_mfma_f32_16x16x32_bf16 v[204:207], v[100:103], v[148:151], v[204:207]
    ds_read_b128 v[100:103], v117 offset:55296
    v_cvt_pk_bf16_f32 v52, v24, v25
    v_cvt_pk_bf16_f32 v53, v26, v27
    v_cvt_pk_bf16_f32 v54, v28, v29
    v_cvt_pk_bf16_f32 v55, v30, v31
    s_waitcnt lgkmcnt(3)
    v_mfma_f32_32x32x16_bf16 v[16:31], v[56:59], v[2:5], 0
    ds_read_b128 v[56:59], v114 offset:28672
    v_exp_f32 v32, v32
    v_exp_f32 v33, v33
    v_exp_f32 v34, v34
    v_mfma_f32_32x32x16_bf16 v[72:87], v[68:71], v[52:55], v[72:87]
    ds_read_b128 v[68:71], v114 offset:23552
    v_exp_f32 v35, v35
    v_exp_f32 v36, v36
    v_exp_f32 v37, v37
    v_smfmac_f32_16x16x64_bf16 v[88:91], v[92:95], v[48:55], v0
    buffer_load_dwordx4 v[140:143], v126, s[8:11], s79 offen offset:256 sc1
    s_add_u32 s79, s79, 0x1000
    s_and_b32 s79, s79, 0x1ffff
    v_exp_f32 v38, v38
    v_mfma_f32_32x32x16_bf16 v[16:31], v[60:63], v[6:9], v[16:31]
    ds_read_b128 v[60:63], v114 offset:29696
    v_exp_f32 v39, v39
    v_exp_f32 v40, v40
    v_cvt_pk_bf16_f32 v48, v32, v33
    v_cvt_pk_bf16_f32 v49, v34, v35
    v_cvt_pk_bf16_f32 v50, v36, v37
    v_cvt_pk_bf16_f32 v51, v38, v39
    s_waitcnt lgkmcnt(3)
    v_mfma_f32_16x16x32_bf16 v[208:211], v[96:99], v[144:147], v[208:211]
    v_exp_f32 v41, v41
    v_mfma_f32_16x16x32_bf16 v[216:219], v[100:103], v[144:147], v[216:219]
    v_exp_f32 v42, v42
    v_mfma_f32_32x32x16_bf16 v[72:87], v[64:67], v[48:51], v[72:87]
    ds_read_b128 v[64:67], v114 offset:26624
    v_exp_f32 v43, v43
    v_exp_f32 v44, v44
    v_exp_f32 v45, v45
    s_add_u32 m0, s80, 40960
    s_and_b32 s84, s83, 0x7ff
    s_add_u32 s83, s83, 0x80
    buffer_load_dwordx4 v10, s[12:15], s84 offen lds
    s_bitcmp1_b32 s83, 11
    s_cselect_b32 s12, s56, s54
    s_cselect_b32 s13, s57, s55
    v_exp_f32 v46, v46
    v_mfma_f32_16x16x32_bf16 v[212:215], v[96:99], v[148:151], v[212:215]
    ds_read_b128 v[96:99], v117 offset:57344
    v_exp_f32 v47, v47
    v_mfma_f32_16x16x32_bf16 v[220:223], v[100:103], v[148:151], v[220:223]
    ds_read_b128 v[100:103], v117 offset:59392
    v_cvt_pk_bf16_f32 v52, v40, v41
    v_cvt_pk_bf16_f32 v53, v42, v43
    v_cvt_pk_bf16_f32 v54, v44, v45
    v_cvt_pk_bf16_f32 v55, v46, v47
    s_waitcnt vmcnt(4) lgkmcnt(4)
    s_barrier
    s_waitcnt lgkmcnt(3)
    v_mfma_f32_32x32x16_bf16 v[32:47], v[56:59], v[2:5], 0
    ds_read_b128 v[56:59], v114 offset:0
    v_exp_f32 v16, v16
    v_exp_f32 v17, v17
    v_exp_f32 v18, v18
    v_mfma_f32_32x32x16_bf16 v[72:87], v[68:71], v[52:55], v[72:87]
    ds_read_b128 v[68:71], v114 offset:27648
    v_exp_f32 v19, v19
    v_exp_f32 v20, v20
    v_exp_f32 v21, v21
    v_smfmac_f32_16x16x64_bf16 v[88:91], v[92:95], v[48:55], v0
    s_add_u32 m0, s80, 16384
    s_add_u32 s78, s78, 0x2000
    s_and_b32 s78, s78, 0x3ffff
    buffer_load_dwordx4 v125, s[8:11], s78 offen sc1 lds
    v_exp_f32 v22, v22
    v_mfma_f32_32x32x16_bf16 v[32:47], v[60:63], v[6:9], v[32:47]
    ds_read_b128 v[60:63], v114 offset:1024
    v_exp_f32 v23, v23
    v_exp_f32 v24, v24
    v_cvt_pk_bf16_f32 v48, v16, v17
    v_cvt_pk_bf16_f32 v49, v18, v19
    v_cvt_pk_bf16_f32 v50, v20, v21
    v_cvt_pk_bf16_f32 v51, v22, v23
    s_waitcnt lgkmcnt(3)
    v_mfma_f32_16x16x32_bf16 v[192:195], v[96:99], v[152:155], v[192:195]
    v_exp_f32 v25, v25
    v_mfma_f32_16x16x32_bf16 v[200:203], v[100:103], v[152:155], v[200:203]
    v_exp_f32 v26, v26
    v_mfma_f32_32x32x16_bf16 v[72:87], v[64:67], v[48:51], v[72:87]
    ds_read_b128 v[64:67], v114 offset:30720
    v_exp_f32 v27, v27
    v_exp_f32 v28, v28
    v_exp_f32 v29, v29
    buffer_load_dwordx4 v[144:147], v126, s[8:11], s79 offen sc1
    v_exp_f32 v30, v30
    v_mfma_f32_16x16x32_bf16 v[196:199], v[96:99], v[156:159], v[196:199]
    ds_read_b128 v[96:99], v117 offset:61440
    v_exp_f32 v31, v31
    v_mfma_f32_16x16x32_bf16 v[204:207], v[100:103], v[156:159], v[204:207]
    ds_read_b128 v[100:103], v117 offset:63488
    v_cvt_pk_bf16_f32 v52, v24, v25
    v_cvt_pk_bf16_f32 v53, v26, v27
    v_cvt_pk_bf16_f32 v54, v28, v29
    v_cvt_pk_bf16_f32 v55, v30, v31
    s_waitcnt lgkmcnt(3)
    v_mfma_f32_32x32x16_bf16 v[16:31], v[56:59], v[2:5], 0
    ds_read_b128 v[56:59], v114 offset:4096
    v_exp_f32 v32, v32
    v_exp_f32 v33, v33
    v_exp_f32 v34, v34
    v_mfma_f32_32x32x16_bf16 v[72:87], v[68:71], v[52:55], v[72:87]
    ds_read_b128 v[68:71], v114 offset:31744
    v_exp_f32 v35, v35
    v_exp_f32 v36, v36
    v_exp_f32 v37, v37
    v_smfmac_f32_16x16x64_bf16 v[88:91], v[92:95], v[48:55], v0
    buffer_load_dwordx4 v[148:151], v126, s[8:11], s79 offen offset:256 sc1
    s_add_u32 s79, s79, 0x1000
    s_and_b32 s79, s79, 0x1ffff
    v_exp_f32 v38, v38
    v_mfma_f32_32x32x16_bf16 v[16:31], v[60:63], v[6:9], v[16:31]
    ds_read_b128 v[60:63], v114 offset:5120
    v_exp_f32 v39, v39
    v_exp_f32 v40, v40
    v_cvt_pk_bf16_f32 v48, v32, v33
    v_cvt_pk_bf16_f32 v49, v34, v35
    v_cvt_pk_bf16_f32 v50, v36, v37
    v_cvt_pk_bf16_f32 v51, v38, v39
    s_waitcnt lgkmcnt(3)
    v_mfma_f32_16x16x32_bf16 v[208:211], v[96:99], v[152:155], v[208:211]
    v_exp_f32 v41, v41
    v_mfma_f32_16x16x32_bf16 v[216:219], v[100:103], v[152:155], v[216:219]
    v_exp_f32 v42, v42
    v_mfma_f32_32x32x16_bf16 v[72:87], v[64:67], v[48:51], v[72:87]
    ds_read_b128 v[64:67], v114 offset:2048
    v_exp_f32 v43, v43
    v_exp_f32 v44, v44
    v_exp_f32 v45, v45
    s_add_u32 m0, s80, 49152
    s_and_b32 s84, s83, 0x7ff
    s_add_u32 s83, s83, 0x80
    buffer_load_dwordx4 v10, s[12:15], s84 offen lds
    s_bitcmp1_b32 s83, 11
    s_cselect_b32 s12, s56, s54
    s_cselect_b32 s13, s57, s55
    v_exp_f32 v46, v46
    v_mfma_f32_16x16x32_bf16 v[212:215], v[96:99], v[156:159], v[212:215]
    ds_read_b128 v[96:99], v117 offset:32768
    v_exp_f32 v47, v47
    v_mfma_f32_16x16x32_bf16 v[220:223], v[100:103], v[156:159], v[220:223]
    ds_read_b128 v[100:103], v117 offset:34816
    v_cvt_pk_bf16_f32 v52, v40, v41
    v_cvt_pk_bf16_f32 v53, v42, v43
    v_cvt_pk_bf16_f32 v54, v44, v45
    v_cvt_pk_bf16_f32 v55, v46, v47
    s_add_u32 s28, s28, 1
    s_cmp_lt_u32 s28, 3
    s_cbranch_scc1 L_gl
    s_waitcnt vmcnt(4) lgkmcnt(4)
    s_barrier
    s_waitcnt lgkmcnt(3)
    v_mfma_f32_32x32x16_bf16 v[32:47], v[56:59], v[2:5], 0
    ds_read_b128 v[56:59], v114 offset:8192
    v_exp_f32 v16, v16
    v_exp_f32 v17, v17
    v_exp_f32 v18, v18
    v_mfma_f32_32x32x16_bf16 v[72:87], v[68:71], v[52:55], v[72:87]
    ds_read_b128 v[68:71], v114 offset:3072
    v_exp_f32 v19, v19
    v_exp_f32 v20, v20
    v_exp_f32 v21, v21
    v_smfmac_f32_16x16x64_bf16 v[88:91], v[92:95], v[48:55], v0
    s_add_u32 m0, s80, 24576
    s_add_u32 s78, s78, 0x2000
    s_and_b32 s78, s78, 0x3ffff
    buffer_load_dwordx4 v125, s[8:11], s78 offen sc1 lds
    v_exp_f32 v22, v22
    v_mfma_f32_32x32x16_bf16 v[32:47], v[60:63], v[6:9], v[32:47]
    ds_read_b128 v[60:63], v114 offset:9216
    v_exp_f32 v23, v23
    v_exp_f32 v24, v24
    buffer_load_dwordx4 v[152:155], v126, s[8:11], s79 offen sc1
    v_cvt_pk_bf16_f32 v48, v16, v17
    v_cvt_pk_bf16_f32 v49, v18, v19
    v_cvt_pk_bf16_f32 v50, v20, v21
    v_cvt_pk_bf16_f32 v51, v22, v23
    s_waitcnt lgkmcnt(3)
    v_mfma_f32_16x16x32_bf16 v[192:195], v[96:99], v[128:131], v[192:195]
    v_exp_f32 v25, v25
    v_mfma_f32_16x16x32_bf16 v[200:203], v[100:103], v[128:131], v[200:203]
    v_exp_f32 v26, v26
    v_mfma_f32_32x32x16_bf16 v[72:87], v[64:67], v[48:51], v[72:87]
    ds_read_b128 v[64:67], v114 offset:6144
    v_exp_f32 v27, v27
    v_exp_f32 v28, v28
    v_exp_f32 v29, v29
    buffer_load_dwordx4 v[156:159], v126, s[8:11], s79 offen offset:256 sc1
    s_add_u32 s79, s79, 0x1000
    s_and_b32 s79, s79, 0x1ffff
    v_exp_f32 v30, v30
    v_mfma_f32_16x16x32_bf16 v[196:199], v[96:99], v[132:135], v[196:199]
    ds_read_b128 v[96:99], v117 offset:36864
    v_exp_f32 v31, v31
    v_mfma_f32_16x16x32_bf16 v[204:207], v[100:103], v[132:135], v[204:207]
    ds_read_b128 v[100:103], v117 offset:38912
    v_cvt_pk_bf16_f32 v52, v24, v25
    v_cvt_pk_bf16_f32 v53, v26, v27
    v_cvt_pk_bf16_f32 v54, v28, v29
    v_cvt_pk_bf16_f32 v55, v30, v31
    s_waitcnt lgkmcnt(3)
    v_mfma_f32_32x32x16_bf16 v[16:31], v[56:59], v[2:5], 0
    ds_read_b128 v[56:59], v114 offset:12288
    v_exp_f32 v32, v32
    v_exp_f32 v33, v33
    v_exp_f32 v34, v34
    v_mfma_f32_32x32x16_bf16 v[72:87], v[68:71], v[52:55], v[72:87]
    ds_read_b128 v[68:71], v114 offset:7168
    v_exp_f32 v35, v35
    v_exp_f32 v36, v36
    v_exp_f32 v37, v37
    v_smfmac_f32_16x16x64_bf16 v[88:91], v[92:95], v[48:55], v0
    s_add_u32 m0, s80, 57344
    s_and_b32 s84, s83, 0x7ff
    s_add_u32 s83, s83, 0x80
    buffer_load_dwordx4 v10, s[12:15], s84 offen lds
    s_bitcmp1_b32 s83, 11
    s_cselect_b32 s12, s56, s54
    s_cselect_b32 s13, s57, s55
    v_exp_f32 v38, v38
    v_mfma_f32_32x32x16_bf16 v[16:31], v[60:63], v[6:9], v[16:31]
    ds_read_b128 v[60:63], v114 offset:13312
    v_exp_f32 v39, v39
    v_exp_f32 v40, v40
    s_lshl_b32 s34, s81, 5
    v_lshrrev_b32 v13, 3, v1
    v_add_u32 v13, s34, v13
    s_lshl_b32 s34, s27, 6
    s_lshl_b32 s35, s87, 5
    s_add_u32 s34, s34, s35
    v_and_b32 v15, 7, v1
    v_lshl_add_u32 v15, v15, 2, s34
    v_lshl_add_u32 v13, v13, 10, v15
    v_lshlrev_b32 v127, 2, v13
    v_lshlrev_b32 v13, 1, v13
    v_lshlrev_b32 v15, 1, v15
    s_movk_i32 s88, 0x4000
    s_mov_b32 s89, 0x8000
    s_mov_b32 s90, 0xc000
    global_load_dwordx2 v[112:113], v15, s[60:61]
    buffer_load_dwordx2 v[240:241], v13, s[4:7], 0 offen
    buffer_load_dwordx2 v[242:243], v13, s[4:7], s88 offen
    v_cvt_pk_bf16_f32 v48, v32, v33
    v_cvt_pk_bf16_f32 v49, v34, v35
    v_cvt_pk_bf16_f32 v50, v36, v37
    v_cvt_pk_bf16_f32 v51, v38, v39
    s_waitcnt lgkmcnt(3)
    v_mfma_f32_16x16x32_bf16 v[208:211], v[96:99], v[128:131], v[208:211]
    v_exp_f32 v41, v41
    v_mfma_f32_16x16x32_bf16 v[216:219], v[100:103], v[128:131], v[216:219]
    v_exp_f32 v42, v42
    v_mfma_f32_32x32x16_bf16 v[72:87], v[64:67], v[48:51], v[72:87]
    ds_read_b128 v[64:67], v114 offset:10240
    v_exp_f32 v43, v43
    v_exp_f32 v44, v44
    v_exp_f32 v45, v45
    buffer_load_dwordx2 v[244:245], v13, s[4:7], s89 offen
    buffer_load_dwordx2 v[246:247], v13, s[4:7], s90 offen
    v_exp_f32 v46, v46
    v_mfma_f32_16x16x32_bf16 v[212:215], v[96:99], v[132:135], v[212:215]
    ds_read_b128 v[96:99], v117 offset:40960
    v_exp_f32 v47, v47
    v_mfma_f32_16x16x32_bf16 v[220:223], v[100:103], v[132:135], v[220:223]
    ds_read_b128 v[100:103], v117 offset:43008
    v_cvt_pk_bf16_f32 v52, v40, v41
    v_cvt_pk_bf16_f32 v53, v42, v43
    v_cvt_pk_bf16_f32 v54, v44, v45
    v_cvt_pk_bf16_f32 v55, v46, v47
    s_waitcnt vmcnt(9) lgkmcnt(4)
    s_barrier
    s_waitcnt lgkmcnt(3)
    v_mfma_f32_32x32x16_bf16 v[32:47], v[56:59], v[2:5], 0
    ds_read_b128 v[56:59], v114 offset:16384
    v_exp_f32 v16, v16
    v_exp_f32 v17, v17
    v_exp_f32 v18, v18
    v_mfma_f32_32x32x16_bf16 v[72:87], v[68:71], v[52:55], v[72:87]
    ds_read_b128 v[68:71], v114 offset:11264
    v_exp_f32 v19, v19
    v_exp_f32 v20, v20
    v_exp_f32 v21, v21
    v_smfmac_f32_16x16x64_bf16 v[88:91], v[92:95], v[48:55], v0
    s_add_u32 m0, s80, 0
    s_add_u32 s78, s78, 0x2000
    s_and_b32 s78, s78, 0x3ffff
    buffer_load_dwordx4 v125, s[8:11], s78 offen sc1 lds
    v_exp_f32 v22, v22
    v_mfma_f32_32x32x16_bf16 v[32:47], v[60:63], v[6:9], v[32:47]
    ds_read_b128 v[60:63], v114 offset:17408
    v_exp_f32 v23, v23
    v_exp_f32 v24, v24
    v_cvt_pk_bf16_f32 v48, v16, v17
    v_cvt_pk_bf16_f32 v49, v18, v19
    v_cvt_pk_bf16_f32 v50, v20, v21
    v_cvt_pk_bf16_f32 v51, v22, v23
    s_waitcnt lgkmcnt(3)
    v_mfma_f32_16x16x32_bf16 v[192:195], v[96:99], v[136:139], v[192:195]
    v_exp_f32 v25, v25
    v_mfma_f32_16x16x32_bf16 v[200:203], v[100:103], v[136:139], v[200:203]
    v_exp_f32 v26, v26
    v_mfma_f32_32x32x16_bf16 v[72:87], v[64:67], v[48:51], v[72:87]
    ds_read_b128 v[64:67], v114 offset:14336
    v_exp_f32 v27, v27
    v_exp_f32 v28, v28
    v_exp_f32 v29, v29
    buffer_load_dwordx4 v[128:131], v126, s[8:11], s79 offen sc1
    v_exp_f32 v30, v30
    v_mfma_f32_16x16x32_bf16 v[196:199], v[96:99], v[140:143], v[196:199]
    ds_read_b128 v[96:99], v117 offset:45056
    v_exp_f32 v31, v31
    v_mfma_f32_16x16x32_bf16 v[204:207], v[100:103], v[140:143], v[204:207]
    ds_read_b128 v[100:103], v117 offset:47104
    v_cvt_pk_bf16_f32 v52, v24, v25
    v_cvt_pk_bf16_f32 v53, v26, v27
    v_cvt_pk_bf16_f32 v54, v28, v29
    v_cvt_pk_bf16_f32 v55, v30, v31
    s_waitcnt lgkmcnt(3)
    v_mfma_f32_32x32x16_bf16 v[16:31], v[56:59], v[2:5], 0
    ds_read_b128 v[56:59], v114 offset:20480
    v_exp_f32 v32, v32
    v_exp_f32 v33, v33
    v_exp_f32 v34, v34
    v_mfma_f32_32x32x16_bf16 v[72:87], v[68:71], v[52:55], v[72:87]
    ds_read_b128 v[68:71], v114 offset:15360
    v_exp_f32 v35, v35
    v_exp_f32 v36, v36
    v_exp_f32 v37, v37
    v_smfmac_f32_16x16x64_bf16 v[88:91], v[92:95], v[48:55], v0
    buffer_load_dwordx4 v[132:135], v126, s[8:11], s79 offen offset:256 sc1
    s_add_u32 s79, s79, 0x1000
    s_and_b32 s79, s79, 0x1ffff
    v_exp_f32 v38, v38
    v_mfma_f32_32x32x16_bf16 v[16:31], v[60:63], v[6:9], v[16:31]
    ds_read_b128 v[60:63], v114 offset:21504
    v_exp_f32 v39, v39
    v_exp_f32 v40, v40
    v_cvt_pk_bf16_f32 v48, v32, v33
    v_cvt_pk_bf16_f32 v49, v34, v35
    v_cvt_pk_bf16_f32 v50, v36, v37
    v_cvt_pk_bf16_f32 v51, v38, v39
    s_waitcnt lgkmcnt(3)
    v_mfma_f32_16x16x32_bf16 v[208:211], v[96:99], v[136:139], v[208:211]
    v_exp_f32 v41, v41
    v_mfma_f32_16x16x32_bf16 v[216:219], v[100:103], v[136:139], v[216:219]
    v_exp_f32 v42, v42
    v_mfma_f32_32x32x16_bf16 v[72:87], v[64:67], v[48:51], v[72:87]
    ds_read_b128 v[64:67], v114 offset:18432
    v_exp_f32 v43, v43
    v_exp_f32 v44, v44
    v_exp_f32 v45, v45
    s_add_u32 m0, s80, 32768
    s_and_b32 s84, s83, 0x7ff
    s_add_u32 s83, s83, 0x80
    buffer_load_dwordx4 v10, s[12:15], s84 offen lds
    s_bitcmp1_b32 s83, 11
    s_cselect_b32 s12, s56, s54
    s_cselect_b32 s13, s57, s55
    v_exp_f32 v46, v46
    v_mfma_f32_16x16x32_bf16 v[212:215], v[96:99], v[140:143], v[212:215]
    ds_read_b128 v[96:99], v117 offset:49152
    v_exp_f32 v47, v47
    v_mfma_f32_16x16x32_bf16 v[220:223], v[100:103], v[140:143], v[220:223]
    ds_read_b128 v[100:103], v117 offset:51200
    v_cvt_pk_bf16_f32 v52, v40, v41
    v_cvt_pk_bf16_f32 v53, v42, v43
    v_cvt_pk_bf16_f32 v54, v44, v45
    v_cvt_pk_bf16_f32 v55, v46, v47
    s_waitcnt vmcnt(4) lgkmcnt(4)
    s_barrier
    s_waitcnt lgkmcnt(3)
    v_mfma_f32_32x32x16_bf16 v[32:47], v[56:59], v[2:5], 0
    ds_read_b128 v[56:59], v114 offset:24576
    v_exp_f32 v16, v16
    v_exp_f32 v17, v17
    v_exp_f32 v18, v18
    v_mfma_f32_32x32x16_bf16 v[72:87], v[68:71], v[52:55], v[72:87]
    ds_read_b128 v[68:71], v114 offset:19456
    v_exp_f32 v19, v19
    v_exp_f32 v20, v20
    v_exp_f32 v21, v21
    v_smfmac_f32_16x16x64_bf16 v[88:91], v[92:95], v[48:55], v0
    s_add_u32 m0, s80, 8192
    s_add_u32 s78, s78, 0x2000
    s_and_b32 s78, s78, 0x3ffff
    buffer_load_dwordx4 v125, s[8:11], s78 offen sc1 lds
    v_exp_f32 v22, v22
    v_mfma_f32_32x32x16_bf16 v[32:47], v[60:63], v[6:9], v[32:47]
    ds_read_b128 v[60:63], v114 offset:25600
    v_exp_f32 v23, v23
    v_exp_f32 v24, v24
    buffer_load_dwordx4 v[136:139], v126, s[8:11], s79 offen sc1
    v_cvt_pk_bf16_f32 v48, v16, v17
    v_cvt_pk_bf16_f32 v49, v18, v19
    v_cvt_pk_bf16_f32 v50, v20, v21
    v_cvt_pk_bf16_f32 v51, v22, v23
    s_waitcnt lgkmcnt(3)
    v_mfma_f32_16x16x32_bf16 v[192:195], v[96:99], v[144:147], v[192:195]
    v_exp_f32 v25, v25
    v_mfma_f32_16x16x32_bf16 v[200:203], v[100:103], v[144:147], v[200:203]
    v_exp_f32 v26, v26
    v_mfma_f32_32x32x16_bf16 v[72:87], v[64:67], v[48:51], v[72:87]
    ds_read_b128 v[64:67], v114 offset:22528
    v_exp_f32 v27, v27
    v_exp_f32 v28, v28
    v_exp_f32 v29, v29
    buffer_load_dwordx4 v[140:143], v126, s[8:11], s79 offen offset:256 sc1
    s_add_u32 s79, s79, 0x1000
    s_and_b32 s79, s79, 0x1ffff
    v_exp_f32 v30, v30
    v_mfma_f32_16x16x32_bf16 v[196:199], v[96:99], v[148:151], v[196:199]
    ds_read_b128 v[96:99], v117 offset:53248
    v_exp_f32 v31, v31
    v_mfma_f32_16x16x32_bf16 v[204:207], v[100:103], v[148:151], v[204:207]
    ds_read_b128 v[100:103], v117 offset:55296
    v_cvt_pk_bf16_f32 v52, v24, v25
    v_cvt_pk_bf16_f32 v53, v26, v27
    v_cvt_pk_bf16_f32 v54, v28, v29
    v_cvt_pk_bf16_f32 v55, v30, v31
    s_waitcnt lgkmcnt(3)
    v_mfma_f32_32x32x16_bf16 v[16:31], v[56:59], v[2:5], 0
    ds_read_b128 v[56:59], v114 offset:28672
    v_exp_f32 v32, v32
    v_exp_f32 v33, v33
    v_exp_f32 v34, v34
    v_mfma_f32_32x32x16_bf16 v[72:87], v[68:71], v[52:55], v[72:87]
    ds_read_b128 v[68:71], v114 offset:23552
    v_exp_f32 v35, v35
    v_exp_f32 v36, v36
    v_exp_f32 v37, v37
    v_smfmac_f32_16x16x64_bf16 v[88:91], v[92:95], v[48:55], v0
    s_add_u32 m0, s80, 40960
    s_and_b32 s84, s83, 0x7ff
    s_add_u32 s83, s83, 0x80
    buffer_load_dwordx4 v10, s[12:15], s84 offen lds
    s_bitcmp1_b32 s83, 11
    s_cselect_b32 s12, s56, s54
    s_cselect_b32 s13, s57, s55
    v_exp_f32 v38, v38
    v_mfma_f32_32x32x16_bf16 v[16:31], v[60:63], v[6:9], v[16:31]
    ds_read_b128 v[60:63], v114 offset:29696
    v_exp_f32 v39, v39
    v_exp_f32 v40, v40
    buffer_load_dwordx4 v[160:163], v126, s[8:11], s95 offen sc1
    v_cvt_pk_bf16_f32 v48, v32, v33
    v_cvt_pk_bf16_f32 v49, v34, v35
    v_cvt_pk_bf16_f32 v50, v36, v37
    v_cvt_pk_bf16_f32 v51, v38, v39
    s_waitcnt lgkmcnt(3)
    v_mfma_f32_16x16x32_bf16 v[208:211], v[96:99], v[144:147], v[208:211]
    v_exp_f32 v41, v41
    v_mfma_f32_16x16x32_bf16 v[216:219], v[100:103], v[144:147], v[216:219]
    v_exp_f32 v42, v42
    v_mfma_f32_32x32x16_bf16 v[72:87], v[64:67], v[48:51], v[72:87]
    ds_read_b128 v[64:67], v114 offset:26624
    v_exp_f32 v43, v43
    v_exp_f32 v44, v44
    v_exp_f32 v45, v45
    buffer_load_dwordx4 v[164:167], v126, s[8:11], s95 offen offset:256 sc1
    s_add_u32 s95, s95, 0x1000
    s_and_b32 s95, s95, 0x1ffff
    v_exp_f32 v46, v46
    v_mfma_f32_16x16x32_bf16 v[212:215], v[96:99], v[148:151], v[212:215]
    ds_read_b128 v[96:99], v117 offset:57344
    v_exp_f32 v47, v47
    v_mfma_f32_16x16x32_bf16 v[220:223], v[100:103], v[148:151], v[220:223]
    ds_read_b128 v[100:103], v117 offset:59392
    v_cvt_pk_bf16_f32 v52, v40, v41
    v_cvt_pk_bf16_f32 v53, v42, v43
    v_cvt_pk_bf16_f32 v54, v44, v45
    v_cvt_pk_bf16_f32 v55, v46, v47
    s_waitcnt vmcnt(6) lgkmcnt(4)
    s_barrier
    s_waitcnt lgkmcnt(3)
    v_mfma_f32_32x32x16_bf16 v[32:47], v[56:59], v[2:5], 0
    ds_read_b128 v[56:59], v114 offset:0
    v_exp_f32 v16, v16
    v_exp_f32 v17, v17
    v_exp_f32 v18, v18
    v_mfma_f32_32x32x16_bf16 v[72:87], v[68:71], v[52:55], v[72:87]
    ds_read_b128 v[68:71], v114 offset:27648
    v_exp_f32 v19, v19
    v_exp_f32 v20, v20
    v_exp_f32 v21, v21
    v_smfmac_f32_16x16x64_bf16 v[88:91], v[92:95], v[48:55], v0
    s_add_u32 m0, s80, 16384
    s_add_u32 s78, s78, 0x2000
    s_and_b32 s78, s78, 0x3ffff
    buffer_load_dwordx4 v125, s[8:11], s78 offen sc1 lds
    v_exp_f32 v22, v22
    v_mfma_f32_32x32x16_bf16 v[32:47], v[60:63], v[6:9], v[32:47]
    ds_read_b128 v[60:63], v114 offset:1024
    v_exp_f32 v23, v23
    v_exp_f32 v24, v24
    buffer_load_dwordx4 v[144:147], v126, s[8:11], s79 offen sc1
    v_cvt_pk_bf16_f32 v48, v16, v17
    v_cvt_pk_bf16_f32 v49, v18, v19
    v_cvt_pk_bf16_f32 v50, v20, v21
    v_cvt_pk_bf16_f32 v51, v22, v23
    s_waitcnt lgkmcnt(3)
    v_mfma_f32_16x16x32_bf16 v[192:195], v[96:99], v[152:155], v[192:195]
    v_exp_f32 v25, v25
    v_mfma_f32_16x16x32_bf16 v[200:203], v[100:103], v[152:155], v[200:203]
    v_exp_f32 v26, v26
    v_mfma_f32_32x32x16_bf16 v[72:87], v[64:67], v[48:51], v[72:87]
    ds_read_b128 v[64:67], v114 offset:30720
    v_exp_f32 v27, v27
    v_exp_f32 v28, v28
    v_exp_f32 v29, v29
    buffer_load_dwordx4 v[148:151], v126, s[8:11], s79 offen offset:256 sc1
    s_add_u32 s79, s79, 0x1000
    s_and_b32 s79, s79, 0x1ffff
    v_exp_f32 v30, v30
    v_mfma_f32_16x16x32_bf16 v[196:199], v[96:99], v[156:159], v[196:199]
    ds_read_b128 v[96:99], v117 offset:61440
    v_exp_f32 v31, v31
    v_mfma_f32_16x16x32_bf16 v[204:207], v[100:103], v[156:159], v[204:207]
    ds_read_b128 v[100:103], v117 offset:63488
    v_cvt_pk_bf16_f32 v52, v24, v25
    v_cvt_pk_bf16_f32 v53, v26, v27
    v_cvt_pk_bf16_f32 v54, v28, v29
    v_cvt_pk_bf16_f32 v55, v30, v31
    s_waitcnt lgkmcnt(3)
    v_mfma_f32_32x32x16_bf16 v[16:31], v[56:59], v[2:5], 0
    ds_read_b128 v[56:59], v114 offset:4096
    v_exp_f32 v32, v32
    v_exp_f32 v33, v33
    v_exp_f32 v34, v34
    v_mfma_f32_32x32x16_bf16 v[72:87], v[68:71], v[52:55], v[72:87]
    ds_read_b128 v[68:71], v114 offset:31744
    v_exp_f32 v35, v35
    v_exp_f32 v36, v36
    v_exp_f32 v37, v37
    v_smfmac_f32_16x16x64_bf16 v[88:91], v[92:95], v[48:55], v0
    s_add_u32 m0, s80, 49152
    s_and_b32 s84, s83, 0x7ff
    s_add_u32 s83, s83, 0x80
    buffer_load_dwordx4 v10, s[12:15], s84 offen lds
    s_bitcmp1_b32 s83, 11
    s_cselect_b32 s12, s56, s54
    s_cselect_b32 s13, s57, s55
    v_exp_f32 v38, v38
    v_mfma_f32_32x32x16_bf16 v[16:31], v[60:63], v[6:9], v[16:31]
    ds_read_b128 v[60:63], v114 offset:5120
    v_exp_f32 v39, v39
    v_exp_f32 v40, v40
    buffer_load_dwordx4 v[168:171], v126, s[8:11], s95 offen sc1
    v_cvt_pk_bf16_f32 v48, v32, v33
    v_cvt_pk_bf16_f32 v49, v34, v35
    v_cvt_pk_bf16_f32 v50, v36, v37
    v_cvt_pk_bf16_f32 v51, v38, v39
    s_waitcnt lgkmcnt(3)
    v_mfma_f32_16x16x32_bf16 v[208:211], v[96:99], v[152:155], v[208:211]
    v_exp_f32 v41, v41
    v_mfma_f32_16x16x32_bf16 v[216:219], v[100:103], v[152:155], v[216:219]
    v_exp_f32 v42, v42
    v_mfma_f32_32x32x16_bf16 v[72:87], v[64:67], v[48:51], v[72:87]
    ds_read_b128 v[64:67], v114 offset:2048
    v_exp_f32 v43, v43
    v_exp_f32 v44, v44
    v_exp_f32 v45, v45
    buffer_load_dwordx4 v[172:175], v126, s[8:11], s95 offen offset:256 sc1
    s_add_u32 s95, s95, 0x1000
    s_and_b32 s95, s95, 0x1ffff
    v_exp_f32 v46, v46
    v_mfma_f32_16x16x32_bf16 v[212:215], v[96:99], v[156:159], v[212:215]
    ds_read_b128 v[96:99], v117 offset:32768
    v_exp_f32 v47, v47
    v_mfma_f32_16x16x32_bf16 v[220:223], v[100:103], v[156:159], v[220:223]
    ds_read_b128 v[100:103], v117 offset:34816
    v_cvt_pk_bf16_f32 v52, v40, v41
    v_cvt_pk_bf16_f32 v53, v42, v43
    v_cvt_pk_bf16_f32 v54, v44, v45
    v_cvt_pk_bf16_f32 v55, v46, v47
    s_waitcnt vmcnt(6) lgkmcnt(4)
    s_barrier
    s_waitcnt lgkmcnt(3)
    v_mfma_f32_32x32x16_bf16 v[32:47], v[56:59], v[2:5], 0
    ds_read_b128 v[56:59], v114 offset:8192
    v_exp_f32 v16, v16
    v_exp_f32 v17, v17
    v_exp_f32 v18, v18
    v_mfma_f32_32x32x16_bf16 v[72:87], v[68:71], v[52:55], v[72:87]
    ds_read_b128 v[68:71], v114 offset:3072
    v_exp_f32 v19, v19
    v_exp_f32 v20, v20
    v_exp_f32 v21, v21
    v_smfmac_f32_16x16x64_bf16 v[88:91], v[92:95], v[48:55], v0
    s_add_u32 m0, s80, 24576
    s_add_u32 s78, s78, 0x2000
    s_and_b32 s78, s78, 0x3ffff
    buffer_load_dwordx4 v125, s[8:11], s78 offen sc1 lds
    v_exp_f32 v22, v22
    v_mfma_f32_32x32x16_bf16 v[32:47], v[60:63], v[6:9], v[32:47]
    ds_read_b128 v[60:63], v114 offset:9216
    v_exp_f32 v23, v23
    v_exp_f32 v24, v24
    buffer_load_dwordx4 v[152:155], v126, s[8:11], s79 offen sc1
    v_cvt_pk_bf16_f32 v48, v16, v17
    v_cvt_pk_bf16_f32 v49, v18, v19
    v_cvt_pk_bf16_f32 v50, v20, v21
    v_cvt_pk_bf16_f32 v51, v22, v23
    s_waitcnt lgkmcnt(3)
    v_mfma_f32_16x16x32_bf16 v[192:195], v[96:99], v[128:131], v[192:195]
    v_exp_f32 v25, v25
    v_mfma_f32_16x16x32_bf16 v[200:203], v[100:103], v[128:131], v[200:203]
    v_exp_f32 v26, v26
    v_mfma_f32_32x32x16_bf16 v[72:87], v[64:67], v[48:51], v[72:87]
    ds_read_b128 v[64:67], v114 offset:6144
    v_exp_f32 v27, v27
    v_exp_f32 v28, v28
    v_exp_f32 v29, v29
    buffer_load_dwordx4 v[156:159], v126, s[8:11], s79 offen offset:256 sc1
    s_add_u32 s79, s79, 0x1000
    s_and_b32 s79, s79, 0x1ffff
    v_exp_f32 v30, v30
    v_mfma_f32_16x16x32_bf16 v[196:199], v[96:99], v[132:135], v[196:199]
    ds_read_b128 v[96:99], v117 offset:36864
    v_exp_f32 v31, v31
    v_mfma_f32_16x16x32_bf16 v[204:207], v[100:103], v[132:135], v[204:207]
    ds_read_b128 v[100:103], v117 offset:38912
    v_cvt_pk_bf16_f32 v52, v24, v25
    v_cvt_pk_bf16_f32 v53, v26, v27
    v_cvt_pk_bf16_f32 v54, v28, v29
    v_cvt_pk_bf16_f32 v55, v30, v31
    s_waitcnt lgkmcnt(3)
    v_mfma_f32_32x32x16_bf16 v[16:31], v[56:59], v[2:5], 0
    ds_read_b128 v[56:59], v114 offset:12288
    v_exp_f32 v32, v32
    v_exp_f32 v33, v33
    v_exp_f32 v34, v34
    v_mfma_f32_32x32x16_bf16 v[72:87], v[68:71], v[52:55], v[72:87]
    ds_read_b128 v[68:71], v114 offset:7168
    v_exp_f32 v35, v35
    v_exp_f32 v36, v36
    v_exp_f32 v37, v37
    v_smfmac_f32_16x16x64_bf16 v[88:91], v[92:95], v[48:55], v0
    s_add_u32 m0, s80, 57344
    s_and_b32 s84, s83, 0x7ff
    s_add_u32 s83, s83, 0x80
    buffer_load_dwordx4 v10, s[12:15], s84 offen lds
    s_bitcmp1_b32 s83, 11
    s_cselect_b32 s12, s56, s54
    s_cselect_b32 s13, s57, s55
    v_exp_f32 v38, v38
    v_mfma_f32_32x32x16_bf16 v[16:31], v[60:63], v[6:9], v[16:31]
    ds_read_b128 v[60:63], v114 offset:13312
    v_exp_f32 v39, v39
    v_exp_f32 v40, v40
    buffer_load_dwordx4 v[176:179], v126, s[8:11], s95 offen sc1
    v_cvt_pk_bf16_f32 v48, v32, v33
    v_cvt_pk_bf16_f32 v49, v34, v35
    v_cvt_pk_bf16_f32 v50, v36, v37
    v_cvt_pk_bf16_f32 v51, v38, v39
    s_waitcnt lgkmcnt(3)
    v_mfma_f32_16x16x32_bf16 v[208:211], v[96:99], v[128:131], v[208:211]
    v_exp_f32 v41, v41
    v_mfma_f32_16x16x32_bf16 v[216:219], v[100:103], v[128:131], v[216:219]
    v_exp_f32 v42, v42
    v_mfma_f32_32x32x16_bf16 v[72:87], v[64:67], v[48:51], v[72:87]
    ds_read_b128 v[64:67], v114 offset:10240
    v_exp_f32 v43, v43
    v_exp_f32 v44, v44
    v_exp_f32 v45, v45
    buffer_load_dwordx4 v[180:183], v126, s[8:11], s95 offen offset:256 sc1
    s_add_u32 s95, s95, 0x1000
    s_and_b32 s95, s95, 0x1ffff
    v_exp_f32 v46, v46
    v_mfma_f32_16x16x32_bf16 v[212:215], v[96:99], v[132:135], v[212:215]
    ds_read_b128 v[96:99], v117 offset:40960
    v_exp_f32 v47, v47
    v_mfma_f32_16x16x32_bf16 v[220:223], v[100:103], v[132:135], v[220:223]
    ds_read_b128 v[100:103], v117 offset:43008
    v_cvt_pk_bf16_f32 v52, v40, v41
    v_cvt_pk_bf16_f32 v53, v42, v43
    v_cvt_pk_bf16_f32 v54, v44, v45
    v_cvt_pk_bf16_f32 v55, v46, v47
    s_waitcnt vmcnt(6) lgkmcnt(4)
    s_barrier
    s_waitcnt lgkmcnt(3)
    v_mfma_f32_32x32x16_bf16 v[32:47], v[56:59], v[2:5], 0
    ds_read_b128 v[56:59], v114 offset:16384
    v_exp_f32 v16, v16
    v_exp_f32 v17, v17
    v_exp_f32 v18, v18
    v_mfma_f32_32x32x16_bf16 v[72:87], v[68:71], v[52:55], v[72:87]
    ds_read_b128 v[68:71], v114 offset:11264
    v_exp_f32 v19, v19
    v_exp_f32 v20, v20
    v_exp_f32 v21, v21
    v_smfmac_f32_16x16x64_bf16 v[88:91], v[92:95], v[48:55], v0
    s_add_u32 m0, s80, 32768
    s_and_b32 s84, s83, 0x7ff
    s_add_u32 s83, s83, 0x80
    buffer_load_dwordx4 v10, s[12:15], s84 offen lds
    s_bitcmp1_b32 s83, 11
    s_cselect_b32 s12, s56, s54
    s_cselect_b32 s13, s57, s55
    v_exp_f32 v22, v22
    v_mfma_f32_32x32x16_bf16 v[32:47], v[60:63], v[6:9], v[32:47]
    ds_read_b128 v[60:63], v114 offset:17408
    v_exp_f32 v23, v23
    v_exp_f32 v24, v24
    s_add_u32 m0, s80, 0
    s_and_b32 s84, s83, 0x7ff
    s_add_u32 s83, s83, 0x80
    buffer_load_dwordx4 v10, s[12:15], s84 offen lds
    s_bitcmp1_b32 s83, 11
    s_cselect_b32 s12, s56, s54
    s_cselect_b32 s13, s57, s55
    v_cvt_pk_bf16_f32 v48, v16, v17
    v_cvt_pk_bf16_f32 v49, v18, v19
    v_cvt_pk_bf16_f32 v50, v20, v21
    v_cvt_pk_bf16_f32 v51, v22, v23
    s_waitcnt lgkmcnt(3)
    v_mfma_f32_16x16x32_bf16 v[192:195], v[96:99], v[136:139], v[192:195]
    v_exp_f32 v25, v25
    v_mfma_f32_16x16x32_bf16 v[200:203], v[100:103], v[136:139], v[200:203]
    v_exp_f32 v26, v26
    v_mfma_f32_32x32x16_bf16 v[72:87], v[64:67], v[48:51], v[72:87]
    ds_read_b128 v[64:67], v114 offset:14336
    v_exp_f32 v27, v27
    v_exp_f32 v28, v28
    v_exp_f32 v29, v29
    buffer_load_dwordx4 v[128:131], v126, s[8:11], s79 offen sc1
    v_exp_f32 v30, v30
    v_mfma_f32_16x16x32_bf16 v[196:199], v[96:99], v[140:143], v[196:199]
    ds_read_b128 v[96:99], v117 offset:45056
    v_exp_f32 v31, v31
    v_mfma_f32_16x16x32_bf16 v[204:207], v[100:103], v[140:143], v[204:207]
    ds_read_b128 v[100:103], v117 offset:47104
    v_cvt_pk_bf16_f32 v52, v24, v25
    v_cvt_pk_bf16_f32 v53, v26, v27
    v_cvt_pk_bf16_f32 v54, v28, v29
    v_cvt_pk_bf16_f32 v55, v30, v31
    s_waitcnt lgkmcnt(3)
    v_mfma_f32_32x32x16_bf16 v[16:31], v[56:59], v[2:5], 0
    ds_read_b128 v[56:59], v114 offset:20480
    v_exp_f32 v32, v32
    v_exp_f32 v33, v33
    v_exp_f32 v34, v34
    v_mfma_f32_32x32x16_bf16 v[72:87], v[68:71], v[52:55], v[72:87]
    ds_read_b128 v[68:71], v114 offset:15360
    v_exp_f32 v35, v35
    v_exp_f32 v36, v36
    v_exp_f32 v37, v37
    v_smfmac_f32_16x16x64_bf16 v[88:91], v[92:95], v[48:55], v0
    buffer_load_dwordx4 v[132:135], v126, s[8:11], s79 offen offset:256 sc1
    s_add_u32 s79, s79, 0x1000
    s_and_b32 s79, s79, 0x1ffff
    v_exp_f32 v38, v38
    v_mfma_f32_32x32x16_bf16 v[16:31], v[60:63], v[6:9], v[16:31]
    ds_read_b128 v[60:63], v114 offset:21504
    v_exp_f32 v39, v39
    v_exp_f32 v40, v40
    buffer_load_dwordx4 v[184:187], v126, s[8:11], s95 offen sc1
    v_cvt_pk_bf16_f32 v48, v32, v33
    v_cvt_pk_bf16_f32 v49, v34, v35
    v_cvt_pk_bf16_f32 v50, v36, v37
    v_cvt_pk_bf16_f32 v51, v38, v39
    s_waitcnt lgkmcnt(3)
    v_mfma_f32_16x16x32_bf16 v[208:211], v[96:99], v[136:139], v[208:211]
    v_exp_f32 v41, v41
    v_mfma_f32_16x16x32_bf16 v[216:219], v[100:103], v[136:139], v[216:219]
    v_exp_f32 v42, v42
    v_mfma_f32_32x32x16_bf16 v[72:87], v[64:67], v[48:51], v[72:87]
    ds_read_b128 v[64:67], v114 offset:18432
    v_exp_f32 v43, v43
    v_exp_f32 v44, v44
    v_exp_f32 v45, v45
    buffer_load_dwordx4 v[188:191], v126, s[8:11], s95 offen offset:256 sc1
    s_add_u32 s95, s95, 0x1000
    s_and_b32 s95, s95, 0x1ffff
    v_exp_f32 v46, v46
    v_mfma_f32_16x16x32_bf16 v[212:215], v[96:99], v[140:143], v[212:215]
    ds_read_b128 v[96:99], v117 offset:49152
    v_exp_f32 v47, v47
    v_mfma_f32_16x16x32_bf16 v[220:223], v[100:103], v[140:143], v[220:223]
    ds_read_b128 v[100:103], v117 offset:51200
    v_cvt_pk_bf16_f32 v52, v40, v41
    v_cvt_pk_bf16_f32 v53, v42, v43
    v_cvt_pk_bf16_f32 v54, v44, v45
    v_cvt_pk_bf16_f32 v55, v46, v47
    s_waitcnt vmcnt(6) lgkmcnt(4)
    s_barrier
    s_waitcnt lgkmcnt(3)
    v_mfma_f32_32x32x16_bf16 v[32:47], v[56:59], v[2:5], 0
    ds_read_b128 v[56:59], v114 offset:24576
    v_exp_f32 v16, v16
    v_exp_f32 v17, v17
    v_exp_f32 v18, v18
    v_mfma_f32_32x32x16_bf16 v[72:87], v[68:71], v[52:55], v[72:87]
    ds_read_b128 v[68:71], v114 offset:19456
    v_exp_f32 v19, v19
    v_exp_f32 v20, v20
    v_exp_f32 v21, v21
    v_smfmac_f32_16x16x64_bf16 v[88:91], v[92:95], v[48:55], v0
    s_add_u32 m0, s80, 40960
    s_and_b32 s84, s83, 0x7ff
    s_add_u32 s83, s83, 0x80
    buffer_load_dwordx4 v10, s[12:15], s84 offen lds
    s_bitcmp1_b32 s83, 11
    s_cselect_b32 s12, s56, s54
    s_cselect_b32 s13, s57, s55
    v_exp_f32 v22, v22
    v_mfma_f32_32x32x16_bf16 v[32:47], v[60:63], v[6:9], v[32:47]
    ds_read_b128 v[60:63], v114 offset:25600
    v_exp_f32 v23, v23
    v_exp_f32 v24, v24
    s_add_u32 m0, s80, 8192
    s_and_b32 s84, s83, 0x7ff
    s_add_u32 s83, s83, 0x80
    buffer_load_dwordx4 v10, s[12:15], s84 offen lds
    s_bitcmp1_b32 s83, 11
    s_cselect_b32 s12, s56, s54
    s_cselect_b32 s13, s57, s55
    v_cvt_pk_bf16_f32 v48, v16, v17
    v_cvt_pk_bf16_f32 v49, v18, v19
    v_cvt_pk_bf16_f32 v50, v20, v21
    v_cvt_pk_bf16_f32 v51, v22, v23
    s_waitcnt lgkmcnt(3)
    v_mfma_f32_16x16x32_bf16 v[192:195], v[96:99], v[144:147], v[192:195]
    v_exp_f32 v25, v25
    v_mfma_f32_16x16x32_bf16 v[200:203], v[100:103], v[144:147], v[200:203]
    v_exp_f32 v26, v26
    v_mfma_f32_32x32x16_bf16 v[72:87], v[64:67], v[48:51], v[72:87]
    ds_read_b128 v[64:67], v114 offset:22528
    v_exp_f32 v27, v27
    v_exp_f32 v28, v28
    v_exp_f32 v29, v29
    buffer_load_dwordx4 v[136:139], v126, s[8:11], s79 offen sc1
    v_exp_f32 v30, v30
    v_mfma_f32_16x16x32_bf16 v[196:199], v[96:99], v[148:151], v[196:199]
    ds_read_b128 v[96:99], v117 offset:53248
    v_exp_f32 v31, v31
    v_mfma_f32_16x16x32_bf16 v[204:207], v[100:103], v[148:151], v[204:207]
    ds_read_b128 v[100:103], v117 offset:55296
    v_cvt_pk_bf16_f32 v52, v24, v25
    v_cvt_pk_bf16_f32 v53, v26, v27
    v_cvt_pk_bf16_f32 v54, v28, v29
    v_cvt_pk_bf16_f32 v55, v30, v31
    s_waitcnt lgkmcnt(3)
    v_mfma_f32_32x32x16_bf16 v[16:31], v[56:59], v[2:5], 0
    ds_read_b128 v[56:59], v114 offset:28672
    v_exp_f32 v32, v32
    v_exp_f32 v33, v33
    v_exp_f32 v34, v34
    v_mfma_f32_32x32x16_bf16 v[72:87], v[68:71], v[52:55], v[72:87]
    ds_read_b128 v[68:71], v114 offset:23552
    v_exp_f32 v35, v35
    v_exp_f32 v36, v36
    v_exp_f32 v37, v37
    v_smfmac_f32_16x16x64_bf16 v[88:91], v[92:95], v[48:55], v0
    buffer_load_dwordx4 v[140:143], v126, s[8:11], s79 offen offset:256 sc1
    s_add_u32 s79, s79, 0x1000
    s_and_b32 s79, s79, 0x1ffff
    v_exp_f32 v38, v38
    v_mfma_f32_32x32x16_bf16 v[16:31], v[60:63], v[6:9], v[16:31]
    ds_read_b128 v[60:63], v114 offset:29696
    v_exp_f32 v39, v39
    v_exp_f32 v40, v40
    buffer_load_dwordx4 v[224:227], v126, s[8:11], s95 offen sc1
    v_cvt_pk_bf16_f32 v48, v32, v33
    v_cvt_pk_bf16_f32 v49, v34, v35
    v_cvt_pk_bf16_f32 v50, v36, v37
    v_cvt_pk_bf16_f32 v51, v38, v39
    s_waitcnt lgkmcnt(3)
    v_mfma_f32_16x16x32_bf16 v[208:211], v[96:99], v[144:147], v[208:211]
    v_exp_f32 v41, v41
    v_mfma_f32_16x16x32_bf16 v[216:219], v[100:103], v[144:147], v[216:219]
    v_exp_f32 v42, v42
    v_mfma_f32_32x32x16_bf16 v[72:87], v[64:67], v[48:51], v[72:87]
    ds_read_b128 v[64:67], v114 offset:26624
    v_exp_f32 v43, v43
    v_exp_f32 v44, v44
    v_exp_f32 v45, v45
    buffer_load_dwordx4 v[228:231], v126, s[8:11], s95 offen offset:256 sc1
    s_add_u32 s95, s95, 0x1000
    s_and_b32 s95, s95, 0x1ffff
    v_exp_f32 v46, v46
    v_mfma_f32_16x16x32_bf16 v[212:215], v[96:99], v[148:151], v[212:215]
    ds_read_b128 v[96:99], v117 offset:57344
    v_exp_f32 v47, v47
    v_mfma_f32_16x16x32_bf16 v[220:223], v[100:103], v[148:151], v[220:223]
    ds_read_b128 v[100:103], v117 offset:59392
    v_cvt_pk_bf16_f32 v52, v40, v41
    v_cvt_pk_bf16_f32 v53, v42, v43
    v_cvt_pk_bf16_f32 v54, v44, v45
    v_cvt_pk_bf16_f32 v55, v46, v47
    s_waitcnt vmcnt(6) lgkmcnt(4)
    s_barrier
    s_waitcnt lgkmcnt(3)
    v_mfma_f32_32x32x16_bf16 v[32:47], v[56:59], v[2:5], 0
    ds_read_b128 v[56:59], v114 offset:0
    v_exp_f32 v16, v16
    v_exp_f32 v17, v17
    v_exp_f32 v18, v18
    v_mfma_f32_32x32x16_bf16 v[72:87], v[68:71], v[52:55], v[72:87]
    ds_read_b128 v[68:71], v114 offset:27648
    v_exp_f32 v19, v19
    v_exp_f32 v20, v20
    v_exp_f32 v21, v21
    v_smfmac_f32_16x16x64_bf16 v[88:91], v[92:95], v[48:55], v0
    s_add_u32 m0, s80, 49152
    s_and_b32 s84, s83, 0x7ff
    s_add_u32 s83, s83, 0x80
    buffer_load_dwordx4 v10, s[12:15], s84 offen lds
    s_bitcmp1_b32 s83, 11
    s_cselect_b32 s12, s56, s54
    s_cselect_b32 s13, s57, s55
    v_exp_f32 v22, v22
    v_mfma_f32_32x32x16_bf16 v[32:47], v[60:63], v[6:9], v[32:47]
    ds_read_b128 v[60:63], v114 offset:1024
    v_exp_f32 v23, v23
    v_exp_f32 v24, v24
    s_add_u32 m0, s80, 16384
    s_and_b32 s84, s83, 0x7ff
    s_add_u32 s83, s83, 0x80
    buffer_load_dwordx4 v10, s[12:15], s84 offen lds
    s_bitcmp1_b32 s83, 11
    s_cselect_b32 s12, s56, s54
    s_cselect_b32 s13, s57, s55
    v_cvt_pk_bf16_f32 v48, v16, v17
    v_cvt_pk_bf16_f32 v49, v18, v19
    v_cvt_pk_bf16_f32 v50, v20, v21
    v_cvt_pk_bf16_f32 v51, v22, v23
    s_waitcnt lgkmcnt(3)
    v_mfma_f32_16x16x32_bf16 v[192:195], v[96:99], v[152:155], v[192:195]
    v_exp_f32 v25, v25
    v_mfma_f32_16x16x32_bf16 v[200:203], v[100:103], v[152:155], v[200:203]
    v_exp_f32 v26, v26
    v_mfma_f32_32x32x16_bf16 v[72:87], v[64:67], v[48:51], v[72:87]
    ds_read_b128 v[64:67], v114 offset:30720
    v_exp_f32 v27, v27
    v_exp_f32 v28, v28
    v_exp_f32 v29, v29
    buffer_load_dwordx4 v[144:147], v126, s[8:11], s79 offen sc1
    v_exp_f32 v30, v30
    v_mfma_f32_16x16x32_bf16 v[196:199], v[96:99], v[156:159], v[196:199]
    ds_read_b128 v[96:99], v117 offset:61440
    v_exp_f32 v31, v31
    v_mfma_f32_16x16x32_bf16 v[204:207], v[100:103], v[156:159], v[204:207]
    ds_read_b128 v[100:103], v117 offset:63488
    v_cvt_pk_bf16_f32 v52, v24, v25
    v_cvt_pk_bf16_f32 v53, v26, v27
    v_cvt_pk_bf16_f32 v54, v28, v29
    v_cvt_pk_bf16_f32 v55, v30, v31
    s_waitcnt lgkmcnt(3)
    v_mfma_f32_32x32x16_bf16 v[16:31], v[56:59], v[2:5], 0
    ds_read_b128 v[56:59], v114 offset:4096
    v_exp_f32 v32, v32
    v_exp_f32 v33, v33
    v_exp_f32 v34, v34
    v_mfma_f32_32x32x16_bf16 v[72:87], v[68:71], v[52:55], v[72:87]
    ds_read_b128 v[68:71], v114 offset:31744
    v_exp_f32 v35, v35
    v_exp_f32 v36, v36
    v_exp_f32 v37, v37
    v_smfmac_f32_16x16x64_bf16 v[88:91], v[92:95], v[48:55], v0
    buffer_load_dwordx4 v[148:151], v126, s[8:11], s79 offen offset:256 sc1
    s_add_u32 s79, s79, 0x1000
    s_and_b32 s79, s79, 0x1ffff
    v_exp_f32 v38, v38
    v_mfma_f32_32x32x16_bf16 v[16:31], v[60:63], v[6:9], v[16:31]
    ds_read_b128 v[60:63], v114 offset:5120
    v_exp_f32 v39, v39
    v_exp_f32 v40, v40
    buffer_load_dwordx4 v[232:235], v126, s[8:11], s95 offen sc1
    v_cvt_pk_bf16_f32 v48, v32, v33
    v_cvt_pk_bf16_f32 v49, v34, v35
    v_cvt_pk_bf16_f32 v50, v36, v37
    v_cvt_pk_bf16_f32 v51, v38, v39
    s_waitcnt lgkmcnt(3)
    v_mfma_f32_16x16x32_bf16 v[208:211], v[96:99], v[152:155], v[208:211]
    v_exp_f32 v41, v41
    v_mfma_f32_16x16x32_bf16 v[216:219], v[100:103], v[152:155], v[216:219]
    v_exp_f32 v42, v42
    v_mfma_f32_32x32x16_bf16 v[72:87], v[64:67], v[48:51], v[72:87]
    ds_read_b128 v[64:67], v114 offset:2048
    v_exp_f32 v43, v43
    v_exp_f32 v44, v44
    v_exp_f32 v45, v45
    buffer_load_dwordx4 v[236:239], v126, s[8:11], s95 offen offset:256 sc1
    s_add_u32 s95, s95, 0x1000
    s_and_b32 s95, s95, 0x1ffff
    v_exp_f32 v46, v46
    v_mfma_f32_16x16x32_bf16 v[212:215], v[96:99], v[156:159], v[212:215]
    ds_read_b128 v[96:99], v117 offset:32768
    v_exp_f32 v47, v47
    v_mfma_f32_16x16x32_bf16 v[220:223], v[100:103], v[156:159], v[220:223]
    ds_read_b128 v[100:103], v117 offset:34816
    v_cvt_pk_bf16_f32 v52, v40, v41
    v_cvt_pk_bf16_f32 v53, v42, v43
    v_cvt_pk_bf16_f32 v54, v44, v45
    v_cvt_pk_bf16_f32 v55, v46, v47
    s_waitcnt lgkmcnt(4)
    s_nop 0
    v_mfma_f32_32x32x16_bf16 v[72:87], v[68:71], v[52:55], v[72:87]
    v_smfmac_f32_16x16x64_bf16 v[88:91], v[92:95], v[48:55], v0
    s_mov_b32 s34, 0x21800000
    s_mov_b32 s35, 0x5d800000
    s_nop 8
    v_pk_mul_f32 v[54:55], v[72:73], 0
    v_pk_fma_f32 v[54:55], v[74:75], 0, v[54:55]
    v_pk_fma_f32 v[54:55], v[76:77], 0, v[54:55]
    v_pk_fma_f32 v[54:55], v[78:79], 0, v[54:55]
    v_pk_fma_f32 v[54:55], v[80:81], 0, v[54:55]
    v_pk_fma_f32 v[54:55], v[82:83], 0, v[54:55]
    v_pk_fma_f32 v[54:55], v[84:85], 0, v[54:55]
    v_pk_fma_f32 v[54:55], v[86:87], 0, v[54:55]
    v_add_f32 v88, v88, v89
    v_mov_b32 v90, v88
    v_cmp_nle_f32 s[42:43], s34, v88
    v_cmp_nge_f32 vcc, s35, v88
    s_or_b64 s[42:43], vcc, s[42:43]
    v_cmp_nle_f32 vcc, s34, v90
    s_or_b64 s[42:43], vcc, s[42:43]
    v_cmp_nge_f32 vcc, s35, v90
    s_or_b64 s[42:43], vcc, s[42:43]
    v_cmp_u_f32 vcc, v54, v55
    s_or_b64 s[42:43], vcc, s[42:43]
    s_waitcnt lgkmcnt(1)
    s_cmp_lg_u64 s[42:43], 0
    s_cbranch_scc1 L_fb
L_fbret:
    v_rcp_f32 v88, v88
    v_rcp_f32 v90, v90
    s_lshl_b32 s34, s24, 3
    s_add_u32 s34, s34, s3
    s_lshl_b32 s34, s34, 16
    s_lshl_b32 s35, s25, 11
    s_add_u32 s34, s34, s35
    s_add_u32 s34, s34, 33554432
    v_pk_mul_f32 v[72:73], v[72:73], v[88:89] op_sel_hi:[1,0]
    v_pk_mul_f32 v[74:75], v[74:75], v[88:89] op_sel_hi:[1,0]
    v_pk_mul_f32 v[76:77], v[76:77], v[88:89] op_sel_hi:[1,0]
    v_pk_mul_f32 v[78:79], v[78:79], v[88:89] op_sel_hi:[1,0]
    v_pk_mul_f32 v[80:81], v[80:81], v[90:91] op_sel_hi:[1,0]
    v_pk_mul_f32 v[82:83], v[82:83], v[90:91] op_sel_hi:[1,0]
    v_pk_mul_f32 v[84:85], v[84:85], v[90:91] op_sel_hi:[1,0]
    v_pk_mul_f32 v[86:87], v[86:87], v[90:91] op_sel_hi:[1,0]
    v_cvt_pk_bf16_f32 v56, v72, v73
    v_cvt_pk_bf16_f32 v57, v74, v75
    v_cvt_pk_bf16_f32 v58, v76, v77
    v_cvt_pk_bf16_f32 v59, v78, v79
    v_cvt_pk_bf16_f32 v60, v80, v81
    v_cvt_pk_bf16_f32 v61, v82, v83
    v_cvt_pk_bf16_f32 v62, v84, v85
    v_cvt_pk_bf16_f32 v63, v86, v87
    buffer_store_dwordx4 v[56:59], v114, s[8:11], s34 offen sc1
    buffer_store_dwordx4 v[60:63], v114, s[8:11], s34 offen offset:1024 sc1
    s_waitcnt vmcnt(8) lgkmcnt(4)
    s_barrier
    ds_read_b128 v[104:107], v117 offset:36864
    ds_read_b128 v[108:111], v117 offset:38912
    s_add_u32 m0, s80, 57344
    s_and_b32 s84, s83, 0x7ff
    s_add_u32 s83, s83, 0x80
    buffer_load_dwordx4 v10, s[12:15], s84 offen lds
    s_bitcmp1_b32 s83, 11
    s_cselect_b32 s12, s56, s54
    s_cselect_b32 s13, s57, s55
    s_add_u32 m0, s80, 24576
    s_and_b32 s84, s83, 0x7ff
    s_add_u32 s83, s83, 0x80
    buffer_load_dwordx4 v10, s[12:15], s84 offen lds
    s_bitcmp1_b32 s83, 11
    s_cselect_b32 s12, s56, s54
    s_cselect_b32 s13, s57, s55
    s_waitcnt vmcnt(18) lgkmcnt(3)
    v_mfma_f32_16x16x32_bf16 v[192:195], v[96:99], v[128:131], v[192:195]
    v_mfma_f32_16x16x32_bf16 v[196:199], v[96:99], v[132:135], v[196:199]
    ds_read_b128 v[96:99], v117 offset:0
    buffer_load_dwordx4 v[152:155], v126, s[8:11], s95 offen sc1
    s_waitcnt lgkmcnt(3)
    v_mfma_f32_16x16x32_bf16 v[204:207], v[100:103], v[132:135], v[204:207]
    v_mfma_f32_16x16x32_bf16 v[200:203], v[100:103], v[128:131], v[200:203]
    ds_read_b128 v[100:103], v117 offset:2048
    buffer_load_dwordx4 v[156:159], v126, s[8:11], s95 offen offset:256 sc1
    s_add_u32 s95, s95, 0x1000
    s_and_b32 s95, s95, 0x1ffff
    s_waitcnt lgkmcnt(3)
    v_mfma_f32_16x16x32_bf16 v[208:211], v[104:107], v[128:131], v[208:211]
    v_mfma_f32_16x16x32_bf16 v[212:215], v[104:107], v[132:135], v[212:215]
    ds_read_b128 v[104:107], v117 offset:4096
    s_waitcnt lgkmcnt(3)
    v_mfma_f32_16x16x32_bf16 v[220:223], v[108:111], v[132:135], v[220:223]
    v_mfma_f32_16x16x32_bf16 v[216:219], v[108:111], v[128:131], v[216:219]
    ds_read_b128 v[108:111], v117 offset:6144
    s_waitcnt vmcnt(4)
    s_lshl3_add_u32 s34, s76, s3
    s_lshl_b32 s34, s34, 7
    s_add_u32 s34, s34, 50855936
    v_mov_b32 v13, s34
    v_mov_b32 v14, s40
    v_mov_b32 v15, s41
    s_mov_b64 exec, 1
    buffer_store_dwordx2 v[14:15], v13, s[8:11], 0 offen sc1
    s_mov_b64 exec, -1
    s_waitcnt vmcnt(15) lgkmcnt(3)
    v_mfma_f32_16x16x32_bf16 v[192:195], v[96:99], v[136:139], v[192:195]
    v_mfma_f32_16x16x32_bf16 v[196:199], v[96:99], v[140:143], v[196:199]
    ds_read_b128 v[96:99], v117 offset:40960
    buffer_load_dwordx4 v[128:131], v126, s[8:11], s95 offen sc1
    s_waitcnt lgkmcnt(3)
    v_mfma_f32_16x16x32_bf16 v[204:207], v[100:103], v[140:143], v[204:207]
    v_mfma_f32_16x16x32_bf16 v[200:203], v[100:103], v[136:139], v[200:203]
    ds_read_b128 v[100:103], v117 offset:43008
    buffer_load_dwordx4 v[132:135], v126, s[8:11], s95 offen offset:256 sc1
    s_add_u32 s95, s95, 0x1000
    s_and_b32 s95, s95, 0x1ffff
    s_waitcnt lgkmcnt(3)
    v_mfma_f32_16x16x32_bf16 v[208:211], v[104:107], v[136:139], v[208:211]
    v_mfma_f32_16x16x32_bf16 v[212:215], v[104:107], v[140:143], v[212:215]
    ds_read_b128 v[104:107], v117 offset:45056
    s_waitcnt lgkmcnt(3)
    v_mfma_f32_16x16x32_bf16 v[220:223], v[108:111], v[140:143], v[220:223]
    v_mfma_f32_16x16x32_bf16 v[216:219], v[108:111], v[136:139], v[216:219]
    ds_read_b128 v[108:111], v117 offset:47104
    s_waitcnt vmcnt(11) lgkmcnt(3)
    v_mfma_f32_16x16x32_bf16 v[192:195], v[96:99], v[144:147], v[192:195]
    v_mfma_f32_16x16x32_bf16 v[196:199], v[96:99], v[148:151], v[196:199]
    ds_read_b128 v[96:99], v117 offset:8192
    buffer_load_dwordx4 v[136:139], v126, s[8:11], s95 offen sc1
    s_waitcnt lgkmcnt(3)
    v_mfma_f32_16x16x32_bf16 v[204:207], v[100:103], v[148:151], v[204:207]
    v_mfma_f32_16x16x32_bf16 v[200:203], v[100:103], v[144:147], v[200:203]
    ds_read_b128 v[100:103], v117 offset:10240
    buffer_load_dwordx4 v[140:143], v126, s[8:11], s95 offen offset:256 sc1
    s_add_u32 s95, s95, 0x1000
    s_and_b32 s95, s95, 0x1ffff
    s_waitcnt lgkmcnt(3)
    v_mfma_f32_16x16x32_bf16 v[208:211], v[104:107], v[144:147], v[208:211]
    v_mfma_f32_16x16x32_bf16 v[212:215], v[104:107], v[148:151], v[212:215]
    ds_read_b128 v[104:107], v117 offset:12288
    s_waitcnt lgkmcnt(3)
    v_mfma_f32_16x16x32_bf16 v[220:223], v[108:111], v[148:151], v[220:223]
    v_mfma_f32_16x16x32_bf16 v[216:219], v[108:111], v[144:147], v[216:219]
    ds_read_b128 v[108:111], v117 offset:14336
    s_waitcnt vmcnt(7) lgkmcnt(0)
    s_barrier
    s_waitcnt vmcnt(41) lgkmcnt(3)
    v_mfma_f32_16x16x32_bf16 v[192:195], v[96:99], v[160:163], v[192:195]
    v_mfma_f32_16x16x32_bf16 v[196:199], v[96:99], v[164:167], v[196:199]
    ds_read_b128 v[96:99], v117 offset:49152
    s_add_u32 m0, s80, 32768
    s_and_b32 s84, s83, 0x7ff
    s_add_u32 s83, s83, 0x80
    buffer_load_dwordx4 v10, s[12:15], s84 offen lds
    s_bitcmp1_b32 s83, 11
    s_cselect_b32 s12, s56, s54
    s_cselect_b32 s13, s57, s55
    s_waitcnt lgkmcnt(3)
    v_mfma_f32_16x16x32_bf16 v[204:207], v[100:103], v[164:167], v[204:207]
    v_mfma_f32_16x16x32_bf16 v[200:203], v[100:103], v[160:163], v[200:203]
    ds_read_b128 v[100:103], v117 offset:51200
    s_add_u32 m0, s80, 0
    s_and_b32 s84, s83, 0x7ff
    s_add_u32 s83, s83, 0x80
    buffer_load_dwordx4 v10, s[12:15], s84 offen lds
    s_bitcmp1_b32 s83, 11
    s_cselect_b32 s12, s56, s54
    s_cselect_b32 s13, s57, s55
    s_waitcnt lgkmcnt(3)
    v_mfma_f32_16x16x32_bf16 v[208:211], v[104:107], v[160:163], v[208:211]
    v_mfma_f32_16x16x32_bf16 v[212:215], v[104:107], v[164:167], v[212:215]
    ds_read_b128 v[104:107], v117 offset:53248
    s_add_u32 m0, s80, 40960
    s_and_b32 s84, s83, 0x7ff
    s_add_u32 s83, s83, 0x80
    buffer_load_dwordx4 v10, s[12:15], s84 offen lds
    s_bitcmp1_b32 s83, 11
    s_cselect_b32 s12, s56, s54
    s_cselect_b32 s13, s57, s55
    s_waitcnt lgkmcnt(3)
    v_mfma_f32_16x16x32_bf16 v[220:223], v[108:111], v[164:167], v[220:223]
    v_mfma_f32_16x16x32_bf16 v[216:219], v[108:111], v[160:163], v[216:219]
    ds_read_b128 v[108:111], v117 offset:55296
    s_add_u32 m0, s80, 8192
    s_and_b32 s84, s83, 0x7ff
    s_add_u32 s83, s83, 0x80
    buffer_load_dwordx4 v10, s[12:15], s84 offen lds
    s_bitcmp1_b32 s83, 11
    s_cselect_b32 s12, s56, s54
    s_cselect_b32 s13, s57, s55
    s_waitcnt vmcnt(39) lgkmcnt(3)
    v_mfma_f32_16x16x32_bf16 v[192:195], v[96:99], v[168:171], v[192:195]
    v_mfma_f32_16x16x32_bf16 v[196:199], v[96:99], v[172:175], v[196:199]
    ds_read_b128 v[96:99], v117 offset:16384
    s_waitcnt lgkmcnt(3)
    v_mfma_f32_16x16x32_bf16 v[204:207], v[100:103], v[172:175], v[204:207]
    v_mfma_f32_16x16x32_bf16 v[200:203], v[100:103], v[168:171], v[200:203]
    ds_read_b128 v[100:103], v117 offset:18432
    s_waitcnt lgkmcnt(3)
    v_mfma_f32_16x16x32_bf16 v[208:211], v[104:107], v[168:171], v[208:211]
    v_mfma_f32_16x16x32_bf16 v[212:215], v[104:107], v[172:175], v[212:215]
    ds_read_b128 v[104:107], v117 offset:20480
    s_waitcnt lgkmcnt(3)
    v_mfma_f32_16x16x32_bf16 v[220:223], v[108:111], v[172:175], v[220:223]
    v_mfma_f32_16x16x32_bf16 v[216:219], v[108:111], v[168:171], v[216:219]
    ds_read_b128 v[108:111], v117 offset:22528
    s_waitcnt vmcnt(33) lgkmcnt(3)
    v_mfma_f32_16x16x32_bf16 v[192:195], v[96:99], v[176:179], v[192:195]
    v_mfma_f32_16x16x32_bf16 v[196:199], v[96:99], v[180:183], v[196:199]
    ds_read_b128 v[96:99], v117 offset:57344
    s_waitcnt lgkmcnt(3)
    v_mfma_f32_16x16x32_bf16 v[204:207], v[100:103], v[180:183], v[204:207]
    v_mfma_f32_16x16x32_bf16 v[200:203], v[100:103], v[176:179], v[200:203]
    ds_read_b128 v[100:103], v117 offset:59392
    s_waitcnt lgkmcnt(3)
    v_mfma_f32_16x16x32_bf16 v[208:211], v[104:107], v[176:179], v[208:211]
    v_mfma_f32_16x16x32_bf16 v[212:215], v[104:107], v[180:183], v[212:215]
    ds_read_b128 v[104:107], v117 offset:61440
    s_waitcnt lgkmcnt(3)
    v_mfma_f32_16x16x32_bf16 v[220:223], v[108:111], v[180:183], v[220:223]
    v_mfma_f32_16x16x32_bf16 v[216:219], v[108:111], v[176:179], v[216:219]
    ds_read_b128 v[108:111], v117 offset:63488
    s_waitcnt vmcnt(27) lgkmcnt(3)
    v_mfma_f32_16x16x32_bf16 v[192:195], v[96:99], v[184:187], v[192:195]
    v_mfma_f32_16x16x32_bf16 v[196:199], v[96:99], v[188:191], v[196:199]
    ds_read_b128 v[96:99], v117 offset:24576
    s_waitcnt lgkmcnt(3)
    v_mfma_f32_16x16x32_bf16 v[204:207], v[100:103], v[188:191], v[204:207]
    v_mfma_f32_16x16x32_bf16 v[200:203], v[100:103], v[184:187], v[200:203]
    ds_read_b128 v[100:103], v117 offset:26624
    s_waitcnt lgkmcnt(3)
    v_mfma_f32_16x16x32_bf16 v[208:211], v[104:107], v[184:187], v[208:211]
    v_mfma_f32_16x16x32_bf16 v[212:215], v[104:107], v[188:191], v[212:215]
    ds_read_b128 v[104:107], v117 offset:28672
    s_waitcnt lgkmcnt(3)
    v_mfma_f32_16x16x32_bf16 v[220:223], v[108:111], v[188:191], v[220:223]
    v_mfma_f32_16x16x32_bf16 v[216:219], v[108:111], v[184:187], v[216:219]
    ds_read_b128 v[108:111], v117 offset:30720
    s_waitcnt vmcnt(0) lgkmcnt(0)
    s_barrier
    s_mov_b32 s97, 0
    s_waitcnt lgkmcnt(3)
    v_mfma_f32_16x16x32_bf16 v[192:195], v[96:99], v[224:227], v[192:195]
    v_mfma_f32_16x16x32_bf16 v[196:199], v[96:99], v[228:231], v[196:199]
    ds_read_b128 v[96:99], v117 offset:32768
    s_add_u32 m0, s80, 49152
    s_nop 0
    buffer_load_dwordx4 v12, s[16:19], s82 offen lds
    s_add_u32 s82, s82, 0x20000
    s_and_b32 s82, s82, 0x1fffff
    s_waitcnt lgkmcnt(3)
    v_mfma_f32_16x16x32_bf16 v[204:207], v[100:103], v[228:231], v[204:207]
    v_mfma_f32_16x16x32_bf16 v[200:203], v[100:103], v[224:227], v[200:203]
    ds_read_b128 v[100:103], v117 offset:34816
    s_add_u32 m0, s80, 16384
    s_nop 0
    buffer_load_dwordx4 v12, s[16:19], s82 offen lds
    s_add_u32 s82, s82, 0x20000
    s_and_b32 s82, s82, 0x1fffff
    s_waitcnt lgkmcnt(3)
    v_mfma_f32_16x16x32_bf16 v[208:211], v[104:107], v[224:227], v[208:211]
    v_mfma_f32_16x16x32_bf16 v[212:215], v[104:107], v[228:231], v[212:215]
    ds_read_b128 v[104:107], v117 offset:36864
    s_add_u32 m0, s80, 57344
    s_nop 0
    buffer_load_dwordx4 v12, s[16:19], s82 offen lds
    s_add_u32 s82, s82, 0x20000
    s_and_b32 s82, s82, 0x1fffff
    s_waitcnt lgkmcnt(3)
    v_mfma_f32_16x16x32_bf16 v[220:223], v[108:111], v[228:231], v[220:223]
    v_mfma_f32_16x16x32_bf16 v[216:219], v[108:111], v[224:227], v[216:219]
    ds_read_b128 v[108:111], v117 offset:38912
    s_add_u32 m0, s80, 24576
    s_nop 0
    buffer_load_dwordx4 v12, s[16:19], s82 offen lds
    s_add_u32 s82, s82, 0x20000
    s_and_b32 s82, s82, 0x1fffff
    s_waitcnt lgkmcnt(3)
    v_mfma_f32_16x16x32_bf16 v[192:195], v[96:99], v[232:235], v[192:195]
    v_mfma_f32_16x16x32_bf16 v[196:199], v[96:99], v[236:239], v[196:199]
    ds_read_b128 v[96:99], v117 offset:0
    s_waitcnt lgkmcnt(3)
    v_mfma_f32_16x16x32_bf16 v[204:207], v[100:103], v[236:239], v[204:207]
    v_mfma_f32_16x16x32_bf16 v[200:203], v[100:103], v[232:235], v[200:203]
    ds_read_b128 v[100:103], v117 offset:2048
    s_waitcnt lgkmcnt(3)
    v_mfma_f32_16x16x32_bf16 v[208:211], v[104:107], v[232:235], v[208:211]
    v_mfma_f32_16x16x32_bf16 v[212:215], v[104:107], v[236:239], v[212:215]
    ds_read_b128 v[104:107], v117 offset:4096
    s_waitcnt lgkmcnt(3)
    v_mfma_f32_16x16x32_bf16 v[220:223], v[108:111], v[236:239], v[220:223]
    v_mfma_f32_16x16x32_bf16 v[216:219], v[108:111], v[232:235], v[216:219]
    ds_read_b128 v[108:111], v117 offset:6144
    s_waitcnt lgkmcnt(3)
    v_mfma_f32_16x16x32_bf16 v[192:195], v[96:99], v[152:155], v[192:195]
    v_mfma_f32_16x16x32_bf16 v[196:199], v[96:99], v[156:159], v[196:199]
    ds_read_b128 v[96:99], v117 offset:40960
    s_waitcnt lgkmcnt(3)
    v_mfma_f32_16x16x32_bf16 v[204:207], v[100:103], v[156:159], v[204:207]
    v_mfma_f32_16x16x32_bf16 v[200:203], v[100:103], v[152:155], v[200:203]
    ds_read_b128 v[100:103], v117 offset:43008
    s_waitcnt lgkmcnt(3)
    v_mfma_f32_16x16x32_bf16 v[208:211], v[104:107], v[152:155], v[208:211]
    v_mfma_f32_16x16x32_bf16 v[212:215], v[104:107], v[156:159], v[212:215]
    ds_read_b128 v[104:107], v117 offset:45056
    s_waitcnt lgkmcnt(3)
    v_mfma_f32_16x16x32_bf16 v[220:223], v[108:111], v[156:159], v[220:223]
    v_mfma_f32_16x16x32_bf16 v[216:219], v[108:111], v[152:155], v[216:219]
    ds_read_b128 v[108:111], v117 offset:47104
    s_lshl_b32 s36, s81, 9
    s_add_u32 s36, s36, 196608
    v_lshrrev_b32 v14, 3, v1
    v_lshlrev_b32 v14, 2, v14
    v_bfe_u32 v13, v1, 3, 1
    v_lshlrev_b32 v13, 7, v13
    v_and_b32 v15, 7, v1
    v_lshl_add_u32 v13, v15, 2, v13
    s_mov_b32 s20, s70
    s_mov_b32 s21, s71
    s_mov_b32 s22, 0x800000
    s_mov_b32 s23, 0x20000
    s_and_b32 s34, s3, 1
    s_lshl_b32 s34, s34, 15
    s_and_b32 s35, s3, 2
    s_lshl_b32 s35, s35, 12
    s_add_u32 s34, s34, s35
    s_lshl_b32 s35, s87, 12
    s_add_u32 s34, s34, s35
    s_add_u32 s34, s34, 0
    s_xor_b32 s35, s34, 0x1000
    v_add_u32 v2, s34, v114
    v_add_u32 v3, s35, v114
    v_and_b32 v4, 15, v1
    v_lshrrev_b32 v5, 5, v1
    v_bfe_u32 v6, v1, 4, 1
    v_lshl_add_u32 v5, v6, 1, v5
    v_xor_b32 v5, v5, v15
    v_lshlrev_b32 v5, 4, v5
    v_lshl_add_u32 v4, v4, 7, v5
    v_add_u32 v4, s35, v4
    v_add_u32 v5, 0x800, v4
    v_xor_b32 v6, 64, v4
    v_xor_b32 v7, 64, v5
    v_lshrrev_b32 v8, 3, v1
    v_xor_b32 v9, v15, v8
    v_lshlrev_b32 v9, 4, v9
    v_lshl_add_u32 v8, v8, 7, v9
    v_add_u32 v8, s35, v8
    buffer_load_dwordx2 v[252:253], v124, s[8:11], 0 offen sc1
    s_waitcnt lgkmcnt(3)
    v_mfma_f32_16x16x32_bf16 v[192:195], v[96:99], v[128:131], v[192:195]
    v_mfma_f32_16x16x32_bf16 v[196:199], v[96:99], v[132:135], v[196:199]
    ds_read_b128 v[96:99], v117 offset:8192
    s_waitcnt lgkmcnt(3)
    v_mfma_f32_16x16x32_bf16 v[204:207], v[100:103], v[132:135], v[204:207]
    v_mfma_f32_16x16x32_bf16 v[200:203], v[100:103], v[128:131], v[200:203]
    ds_read_b128 v[100:103], v117 offset:10240
    s_waitcnt lgkmcnt(3)
    v_mfma_f32_16x16x32_bf16 v[208:211], v[104:107], v[128:131], v[208:211]
    v_mfma_f32_16x16x32_bf16 v[212:215], v[104:107], v[132:135], v[212:215]
    ds_read_b128 v[104:107], v117 offset:12288
    s_waitcnt lgkmcnt(3)
    v_mfma_f32_16x16x32_bf16 v[220:223], v[108:111], v[132:135], v[220:223]
    v_mfma_f32_16x16x32_bf16 v[216:219], v[108:111], v[128:131], v[216:219]
    ds_read_b128 v[108:111], v117 offset:14336
    v_xor_b32 v118, 32, v121
    v_xor_b32 v115, 32, v119
    v_xor_b32 v126, 32, v120
    s_waitcnt lgkmcnt(3)
    v_mfma_f32_16x16x32_bf16 v[192:195], v[96:99], v[136:139], v[192:195]
    v_mfma_f32_16x16x32_bf16 v[196:199], v[96:99], v[140:143], v[196:199]
    ds_read_b64_tr_b16 v[96:97], v119 offset:0
    ds_read_b64_tr_b16 v[98:99], v119 offset:1024
    s_waitcnt lgkmcnt(4)
    v_mfma_f32_16x16x32_bf16 v[204:207], v[100:103], v[140:143], v[204:207]
    v_mfma_f32_16x16x32_bf16 v[200:203], v[100:103], v[136:139], v[200:203]
    ds_read_b64_tr_b16 v[100:101], v115 offset:0
    ds_read_b64_tr_b16 v[102:103], v115 offset:1024
    s_waitcnt lgkmcnt(5)
    v_mfma_f32_16x16x32_bf16 v[208:211], v[104:107], v[136:139], v[208:211]
    v_mfma_f32_16x16x32_bf16 v[212:215], v[104:107], v[140:143], v[212:215]
    ds_read_b64_tr_b16 v[104:105], v119 offset:256
    ds_read_b64_tr_b16 v[106:107], v119 offset:1280
    s_waitcnt lgkmcnt(6)
    v_mfma_f32_16x16x32_bf16 v[220:223], v[108:111], v[140:143], v[220:223]
    v_mfma_f32_16x16x32_bf16 v[216:219], v[108:111], v[136:139], v[216:219]
    ds_read_b64_tr_b16 v[108:109], v115 offset:256
    ds_read_b64_tr_b16 v[110:111], v115 offset:1280
    s_barrier
    s_nop 7
    s_cmp_lt_u32 s3, 4
    s_cbranch_scc1 L_xs0
    ds_write_b128 v2, v[192:195] offset:0
    ds_write_b128 v2, v[196:199] offset:1024
    ds_write_b128 v2, v[200:203] offset:2048
    ds_write_b128 v2, v[204:207] offset:3072
    v_pk_mov_b32 v[192:193], v[208:209], v[208:209] op_sel:[0,1]
    v_pk_mov_b32 v[194:195], v[210:211], v[210:211] op_sel:[0,1]
    v_pk_mov_b32 v[196:197], v[212:213], v[212:213] op_sel:[0,1]
    v_pk_mov_b32 v[198:199], v[214:215], v[214:215] op_sel:[0,1]
    v_pk_mov_b32 v[200:201], v[216:217], v[216:217] op_sel:[0,1]
    v_pk_mov_b32 v[202:203], v[218:219], v[218:219] op_sel:[0,1]
    v_pk_mov_b32 v[204:205], v[220:221], v[220:221] op_sel:[0,1]
    v_pk_mov_b32 v[206:207], v[222:223], v[222:223] op_sel:[0,1]
    s_branch L_xe0
L_xs0:
    ds_write_b128 v2, v[208:211] offset:0
    ds_write_b128 v2, v[212:215] offset:1024
    ds_write_b128 v2, v[216:219] offset:2048
    ds_write_b128 v2, v[220:223] offset:3072
L_xe0:
    s_mov_b32 s35, 0
L_sp:
    s_waitcnt vmcnt(0)
    v_cmp_eq_u64 vcc, s[40:41], v[252:253]
    s_add_u32 s35, s35, 1
    s_and_b32 s94, vcc_lo, 0xffff
    s_cmp_eq_u32 s94, 0xffff
    s_cbranch_scc1 L_spd
    s_cmp_ge_u32 s35, 0x40000
    s_cbranch_scc1 L_spd
    s_sleep 2
    buffer_load_dwordx2 v[252:253], v124, s[8:11], 0 offen sc1
    s_branch L_sp
L_spd:
    s_add_u32 s96, s85, 0
    s_and_b32 s96, s96, 65535
    buffer_load_dwordx4 v[16:19], v11, s[8:11], s96 offen sc1
    buffer_load_dwordx4 v[20:23], v11, s[8:11], s96 offen offset:256 sc1
    s_add_u32 s96, s85, 4096
    s_and_b32 s96, s96, 65535
    buffer_load_dwordx4 v[24:27], v11, s[8:11], s96 offen sc1
    buffer_load_dwordx4 v[28:31], v11, s[8:11], s96 offen offset:256 sc1
    s_add_u32 s96, s85, 8192
    s_and_b32 s96, s96, 65535
    buffer_load_dwordx4 v[32:35], v11, s[8:11], s96 offen sc1
    buffer_load_dwordx4 v[36:39], v11, s[8:11], s96 offen offset:256 sc1
    s_waitcnt lgkmcnt(0)
    s_barrier
    ds_read_b128 v[208:211], v3 offset:0
    ds_read_b128 v[212:215], v3 offset:1024
    ds_read_b128 v[216:219], v3 offset:2048
    ds_read_b128 v[220:223], v3 offset:3072
    s_waitcnt lgkmcnt(0)
    v_pk_add_f32 v[192:193], v[192:193], v[208:209]
    v_pk_add_f32 v[194:195], v[194:195], v[210:211]
    ds_write_b128 v4, v[192:195]
    v_pk_add_f32 v[196:197], v[196:197], v[212:213]
    v_pk_add_f32 v[198:199], v[198:199], v[214:215]
    ds_write_b128 v5, v[196:199]
    v_pk_add_f32 v[200:201], v[200:201], v[216:217]
    v_pk_add_f32 v[202:203], v[202:203], v[218:219]
    ds_write_b128 v6, v[200:203]
    v_pk_add_f32 v[204:205], v[204:205], v[220:221]
    v_pk_add_f32 v[206:207], v[206:207], v[222:223]
    ds_write_b128 v7, v[204:207]
    s_waitcnt vmcnt(4) lgkmcnt(15)
    v_mfma_f32_16x16x32_bf16 v[160:163], v[96:99], v[16:19], 0
    v_mfma_f32_16x16x32_bf16 v[164:167], v[96:99], v[20:23], 0
    ds_read_b64_tr_b16 v[96:97], v119 offset:8192
    ds_read_b64_tr_b16 v[98:99], v119 offset:9216
    buffer_load_dword v248, v14, s[8:11], s36 offen offset:0 sc1
    s_add_u32 s96, s85, 12288
    s_and_b32 s96, s96, 65535
    buffer_load_dwordx4 v[40:43], v11, s[8:11], s96 offen sc1
    s_waitcnt lgkmcnt(15)
    v_mfma_f32_16x16x32_bf16 v[172:175], v[100:103], v[20:23], 0
    v_mfma_f32_16x16x32_bf16 v[168:171], v[100:103], v[16:19], 0
    ds_read_b64_tr_b16 v[100:101], v115 offset:8192
    ds_read_b64_tr_b16 v[102:103], v115 offset:9216
    buffer_load_dword v249, v14, s[8:11], s36 offen offset:128 sc1
    ds_read_b128 v[208:211], v8 offset:0
    ds_read_b128 v[212:215], v8 offset:1024
    ds_read_b128 v[216:219], v8 offset:2048
    ds_read_b128 v[220:223], v8 offset:3072
    s_waitcnt lgkmcnt(15)
    v_mfma_f32_16x16x32_bf16 v[176:179], v[104:107], v[16:19], 0
    v_mfma_f32_16x16x32_bf16 v[180:183], v[104:107], v[20:23], 0
    ds_read_b64_tr_b16 v[104:105], v119 offset:8448
    ds_read_b64_tr_b16 v[106:107], v119 offset:9472
    buffer_load_dword v250, v14, s[8:11], s36 offen offset:256 sc1
    buffer_load_dwordx4 v[44:47], v11, s[8:11], s96 offen offset:256 sc1
    s_waitcnt lgkmcnt(15)
    v_mfma_f32_16x16x32_bf16 v[188:191], v[108:111], v[20:23], 0
    v_mfma_f32_16x16x32_bf16 v[184:187], v[108:111], v[16:19], 0
    ds_read_b64_tr_b16 v[108:109], v115 offset:8448
    ds_read_b64_tr_b16 v[110:111], v115 offset:9472
    buffer_load_dword v251, v14, s[8:11], s36 offen offset:384 sc1
    s_waitcnt vmcnt(8) lgkmcnt(10)
    v_mfma_f32_16x16x32_bf16 v[160:163], v[96:99], v[24:27], v[160:163]
    v_mfma_f32_16x16x32_bf16 v[164:167], v[96:99], v[28:31], v[164:167]
    ds_read_b64_tr_b16 v[96:97], v119 offset:16384
    ds_read_b64_tr_b16 v[98:99], v119 offset:17408
    buffer_load_dword v116, v13, s[8:11], s36 offen sc1
    buffer_load_dword v117, v13, s[8:11], s36 offen offset:256 sc1
    s_add_u32 s96, s85, 16384
    s_and_b32 s96, s96, 65535
    buffer_load_dwordx4 v[48:51], v11, s[8:11], s96 offen sc1
    s_waitcnt lgkmcnt(10)
    v_mfma_f32_16x16x32_bf16 v[172:175], v[100:103], v[28:31], v[172:175]
    v_mfma_f32_16x16x32_bf16 v[168:171], v[100:103], v[24:27], v[168:171]
    ds_read_b64_tr_b16 v[100:101], v115 offset:16384
    ds_read_b64_tr_b16 v[102:103], v115 offset:17408
    s_waitcnt lgkmcnt(6)
    v_mfma_f32_16x16x32_bf16 v[176:179], v[104:107], v[24:27], v[176:179]
    v_mfma_f32_16x16x32_bf16 v[180:183], v[104:107], v[28:31], v[180:183]
    ds_read_b64_tr_b16 v[104:105], v119 offset:16640
    ds_read_b64_tr_b16 v[106:107], v119 offset:17664
    buffer_load_dwordx4 v[52:55], v11, s[8:11], s96 offen offset:256 sc1
    s_waitcnt lgkmcnt(6)
    v_mfma_f32_16x16x32_bf16 v[188:191], v[108:111], v[28:31], v[188:191]
    v_mfma_f32_16x16x32_bf16 v[184:187], v[108:111], v[24:27], v[184:187]
    ds_read_b64_tr_b16 v[108:109], v115 offset:16640
    ds_read_b64_tr_b16 v[110:111], v115 offset:17664
    s_waitcnt vmcnt(10) lgkmcnt(6)
    v_mfma_f32_16x16x32_bf16 v[160:163], v[96:99], v[32:35], v[160:163]
    v_mfma_f32_16x16x32_bf16 v[164:167], v[96:99], v[36:39], v[164:167]
    ds_read_b64_tr_b16 v[96:97], v119 offset:24576
    ds_read_b64_tr_b16 v[98:99], v119 offset:25600
    s_add_u32 s96, s85, 20480
    s_and_b32 s96, s96, 65535
    buffer_load_dwordx4 v[56:59], v11, s[8:11], s96 offen sc1
    s_waitcnt lgkmcnt(6)
    v_mfma_f32_16x16x32_bf16 v[172:175], v[100:103], v[36:39], v[172:175]
    v_mfma_f32_16x16x32_bf16 v[168:171], v[100:103], v[32:35], v[168:171]
    ds_read_b64_tr_b16 v[100:101], v115 offset:24576
    ds_read_b64_tr_b16 v[102:103], v115 offset:25600
    s_waitcnt lgkmcnt(6)
    v_mfma_f32_16x16x32_bf16 v[176:179], v[104:107], v[32:35], v[176:179]
    v_mfma_f32_16x16x32_bf16 v[180:183], v[104:107], v[36:39], v[180:183]
    ds_read_b64_tr_b16 v[104:105], v119 offset:24832
    ds_read_b64_tr_b16 v[106:107], v119 offset:25856
    buffer_load_dwordx4 v[60:63], v11, s[8:11], s96 offen offset:256 sc1
    s_waitcnt lgkmcnt(6)
    v_mfma_f32_16x16x32_bf16 v[188:191], v[108:111], v[36:39], v[188:191]
    v_mfma_f32_16x16x32_bf16 v[184:187], v[108:111], v[32:35], v[184:187]
    ds_read_b64_tr_b16 v[108:109], v115 offset:24832
    ds_read_b64_tr_b16 v[110:111], v115 offset:25856
    s_waitcnt vmcnt(7) lgkmcnt(6)
    v_mfma_f32_16x16x32_bf16 v[160:163], v[96:99], v[40:43], v[160:163]
    v_mfma_f32_16x16x32_bf16 v[164:167], v[96:99], v[44:47], v[164:167]
    ds_read_b64_tr_b16 v[96:97], v119 offset:32768
    ds_read_b64_tr_b16 v[98:99], v119 offset:33792
    s_add_u32 s96, s85, 24576
    s_and_b32 s96, s96, 65535
    buffer_load_dwordx4 v[64:67], v11, s[8:11], s96 offen sc1
    s_waitcnt lgkmcnt(6)
    v_mfma_f32_16x16x32_bf16 v[172:175], v[100:103], v[44:47], v[172:175]
    v_mfma_f32_16x16x32_bf16 v[168:171], v[100:103], v[40:43], v[168:171]
    ds_read_b64_tr_b16 v[100:101], v115 offset:32768
    ds_read_b64_tr_b16 v[102:103], v115 offset:33792
    s_waitcnt lgkmcnt(6)
    v_mfma_f32_16x16x32_bf16 v[176:179], v[104:107], v[40:43], v[176:179]
    v_mfma_f32_16x16x32_bf16 v[180:183], v[104:107], v[44:47], v[180:183]
    ds_read_b64_tr_b16 v[104:105], v119 offset:33024
    ds_read_b64_tr_b16 v[106:107], v119 offset:34048
    buffer_load_dwordx4 v[68:71], v11, s[8:11], s96 offen offset:256 sc1
    s_waitcnt lgkmcnt(6)
    v_mfma_f32_16x16x32_bf16 v[188:191], v[108:111], v[44:47], v[188:191]
    v_mfma_f32_16x16x32_bf16 v[184:187], v[108:111], v[40:43], v[184:187]
    ds_read_b64_tr_b16 v[108:109], v115 offset:33024
    ds_read_b64_tr_b16 v[110:111], v115 offset:34048
    s_waitcnt vmcnt(4) lgkmcnt(6)
    v_mfma_f32_16x16x32_bf16 v[160:163], v[96:99], v[48:51], v[160:163]
    v_mfma_f32_16x16x32_bf16 v[164:167], v[96:99], v[52:55], v[164:167]
    ds_read_b64_tr_b16 v[96:97], v119 offset:40960
    ds_read_b64_tr_b16 v[98:99], v119 offset:41984
    s_add_u32 s96, s85, 28672
    s_and_b32 s96, s96, 65535
    buffer_load_dwordx4 v[72:75], v11, s[8:11], s96 offen sc1
    s_waitcnt lgkmcnt(6)
    v_mfma_f32_16x16x32_bf16 v[172:175], v[100:103], v[52:55], v[172:175]
    v_mfma_f32_16x16x32_bf16 v[168:171], v[100:103], v[48:51], v[168:171]
    ds_read_b64_tr_b16 v[100:101], v115 offset:40960
    ds_read_b64_tr_b16 v[102:103], v115 offset:41984
    s_waitcnt lgkmcnt(6)
    v_mfma_f32_16x16x32_bf16 v[176:179], v[104:107], v[48:51], v[176:179]
    v_mfma_f32_16x16x32_bf16 v[180:183], v[104:107], v[52:55], v[180:183]
    ds_read_b64_tr_b16 v[104:105], v119 offset:41216
    ds_read_b64_tr_b16 v[106:107], v119 offset:42240
    buffer_load_dwordx4 v[76:79], v11, s[8:11], s96 offen offset:256 sc1
    s_waitcnt lgkmcnt(6)
    v_mfma_f32_16x16x32_bf16 v[188:191], v[108:111], v[52:55], v[188:191]
    v_mfma_f32_16x16x32_bf16 v[184:187], v[108:111], v[48:51], v[184:187]
    ds_read_b64_tr_b16 v[108:109], v115 offset:41216
    ds_read_b64_tr_b16 v[110:111], v115 offset:42240
    s_waitcnt vmcnt(4) lgkmcnt(6)
    v_mfma_f32_16x16x32_bf16 v[160:163], v[96:99], v[56:59], v[160:163]
    v_mfma_f32_16x16x32_bf16 v[164:167], v[96:99], v[60:63], v[164:167]
    ds_read_b64_tr_b16 v[96:97], v119 offset:49152
    ds_read_b64_tr_b16 v[98:99], v119 offset:50176
    s_add_u32 s96, s85, 32768
    s_and_b32 s96, s96, 65535
    buffer_load_dwordx4 v[80:83], v11, s[8:11], s96 offen sc1
    s_waitcnt vmcnt(9) lgkmcnt(15)
    v_lshlrev_b32 v122, 16, v113
    v_and_b32 v123, 0xffff0000, v113
    v_and_b32 v113, 0xffff0000, v112
    v_lshlrev_b32 v112, 16, v112
    v_sub_f32 v116, 1.0, v116
    v_sub_f32 v117, 1.0, v117
    v_cvt_pk_bf16_f32 v117, v116, v117
    v_lshlrev_b32 v116, 16, v117
    v_and_b32 v117, 0xffff0000, v117
    v_lshlrev_b32 v124, 16, v240
    v_and_b32 v125, 0xffff0000, v240
    v_pk_mul_f32 v[124:125], v[124:125], v[112:113]
    v_cvt_pk_bf16_f32 v125, v124, v125
    v_lshlrev_b32 v124, 16, v125
    v_and_b32 v125, 0xffff0000, v125
    v_pk_add_f32 v[208:209], v[208:209], v[124:125]
    v_mul_f32 v208, v248, v208
    v_mul_f32 v209, v248, v209
    v_lshlrev_b32 v124, 16, v241
    v_and_b32 v125, 0xffff0000, v241
    v_pk_mul_f32 v[124:125], v[124:125], v[122:123]
    v_cvt_pk_bf16_f32 v125, v124, v125
    v_lshlrev_b32 v124, 16, v125
    v_and_b32 v125, 0xffff0000, v125
    v_pk_add_f32 v[210:211], v[210:211], v[124:125]
    v_mul_f32 v210, v248, v210
    v_mul_f32 v211, v248, v211
    s_waitcnt lgkmcnt(6)
    v_mfma_f32_16x16x32_bf16 v[172:175], v[100:103], v[60:63], v[172:175]
    v_mfma_f32_16x16x32_bf16 v[168:171], v[100:103], v[56:59], v[168:171]
    ds_read_b64_tr_b16 v[100:101], v115 offset:49152
    ds_read_b64_tr_b16 v[102:103], v115 offset:50176
    s_waitcnt lgkmcnt(6)
    v_mfma_f32_16x16x32_bf16 v[176:179], v[104:107], v[56:59], v[176:179]
    v_mfma_f32_16x16x32_bf16 v[180:183], v[104:107], v[60:63], v[180:183]
    ds_read_b64_tr_b16 v[104:105], v119 offset:49408
    ds_read_b64_tr_b16 v[106:107], v119 offset:50432
    buffer_load_dwordx4 v[84:87], v11, s[8:11], s96 offen offset:256 sc1
    s_waitcnt lgkmcnt(6)
    v_mfma_f32_16x16x32_bf16 v[188:191], v[108:111], v[60:63], v[188:191]
    v_mfma_f32_16x16x32_bf16 v[184:187], v[108:111], v[56:59], v[184:187]
    ds_read_b64_tr_b16 v[108:109], v115 offset:49408
    ds_read_b64_tr_b16 v[110:111], v115 offset:50432
    v_lshlrev_b32 v124, 16, v242
    v_and_b32 v125, 0xffff0000, v242
    v_pk_mul_f32 v[124:125], v[124:125], v[112:113]
    v_cvt_pk_bf16_f32 v125, v124, v125
    v_lshlrev_b32 v124, 16, v125
    v_and_b32 v125, 0xffff0000, v125
    v_pk_add_f32 v[212:213], v[212:213], v[124:125]
    v_mul_f32 v212, v249, v212
    v_mul_f32 v213, v249, v213
    v_lshlrev_b32 v124, 16, v243
    v_and_b32 v125, 0xffff0000, v243
    v_pk_mul_f32 v[124:125], v[124:125], v[122:123]
    v_cvt_pk_bf16_f32 v125, v124, v125
    v_lshlrev_b32 v124, 16, v125
    v_and_b32 v125, 0xffff0000, v125
    v_pk_add_f32 v[214:215], v[214:215], v[124:125]
    v_mul_f32 v214, v249, v214
    v_mul_f32 v215, v249, v215
    s_waitcnt vmcnt(4) lgkmcnt(6)
    v_mfma_f32_16x16x32_bf16 v[160:163], v[96:99], v[64:67], v[160:163]
    v_mfma_f32_16x16x32_bf16 v[164:167], v[96:99], v[68:71], v[164:167]
    ds_read_b64_tr_b16 v[96:97], v119 offset:57344
    ds_read_b64_tr_b16 v[98:99], v119 offset:58368
    s_add_u32 s96, s85, 36864
    s_and_b32 s96, s96, 65535
    buffer_load_dwordx4 v[88:91], v11, s[8:11], s96 offen sc1
    s_waitcnt lgkmcnt(6)
    v_mfma_f32_16x16x32_bf16 v[172:175], v[100:103], v[68:71], v[172:175]
    v_mfma_f32_16x16x32_bf16 v[168:171], v[100:103], v[64:67], v[168:171]
    ds_read_b64_tr_b16 v[100:101], v115 offset:57344
    ds_read_b64_tr_b16 v[102:103], v115 offset:58368
    s_waitcnt lgkmcnt(6)
    v_mfma_f32_16x16x32_bf16 v[176:179], v[104:107], v[64:67], v[176:179]
    v_mfma_f32_16x16x32_bf16 v[180:183], v[104:107], v[68:71], v[180:183]
    ds_read_b64_tr_b16 v[104:105], v119 offset:57600
    ds_read_b64_tr_b16 v[106:107], v119 offset:58624
    buffer_load_dwordx4 v[92:95], v11, s[8:11], s96 offen offset:256 sc1
    v_lshlrev_b32 v124, 16, v244
    v_and_b32 v125, 0xffff0000, v244
    v_pk_mul_f32 v[124:125], v[124:125], v[112:113]
    v_cvt_pk_bf16_f32 v125, v124, v125
    v_lshlrev_b32 v124, 16, v125
    v_and_b32 v125, 0xffff0000, v125
    v_pk_add_f32 v[216:217], v[216:217], v[124:125]
    v_mul_f32 v216, v250, v216
    v_mul_f32 v217, v250, v217
    v_lshlrev_b32 v124, 16, v245
    v_and_b32 v125, 0xffff0000, v245
    v_pk_mul_f32 v[124:125], v[124:125], v[122:123]
    v_cvt_pk_bf16_f32 v125, v124, v125
    v_lshlrev_b32 v124, 16, v125
    v_and_b32 v125, 0xffff0000, v125
    v_pk_add_f32 v[218:219], v[218:219], v[124:125]
    v_mul_f32 v218, v250, v218
    v_mul_f32 v219, v250, v219
    s_waitcnt lgkmcnt(6)
    v_mfma_f32_16x16x32_bf16 v[188:191], v[108:111], v[68:71], v[188:191]
    v_mfma_f32_16x16x32_bf16 v[184:187], v[108:111], v[64:67], v[184:187]
    ds_read_b64_tr_b16 v[108:109], v115 offset:57600
    ds_read_b64_tr_b16 v[110:111], v115 offset:58624
    s_waitcnt vmcnt(4) lgkmcnt(6)
    v_mfma_f32_16x16x32_bf16 v[160:163], v[96:99], v[72:75], v[160:163]
    v_mfma_f32_16x16x32_bf16 v[164:167], v[96:99], v[76:79], v[164:167]
    ds_read_b64_tr_b16 v[96:97], v120 offset:0
    ds_read_b64_tr_b16 v[98:99], v120 offset:1024
    s_add_u32 s96, s85, 40960
    s_and_b32 s96, s96, 65535
    buffer_load_dwordx4 v[224:227], v11, s[8:11], s96 offen sc1
    s_waitcnt lgkmcnt(6)
    v_mfma_f32_16x16x32_bf16 v[172:175], v[100:103], v[76:79], v[172:175]
    v_mfma_f32_16x16x32_bf16 v[168:171], v[100:103], v[72:75], v[168:171]
    ds_read_b64_tr_b16 v[100:101], v126 offset:0
    ds_read_b64_tr_b16 v[102:103], v126 offset:1024
    v_lshlrev_b32 v124, 16, v246
    v_and_b32 v125, 0xffff0000, v246
    v_pk_mul_f32 v[124:125], v[124:125], v[112:113]
    v_cvt_pk_bf16_f32 v125, v124, v125
    v_lshlrev_b32 v124, 16, v125
    v_and_b32 v125, 0xffff0000, v125
    v_pk_add_f32 v[220:221], v[220:221], v[124:125]
    v_mul_f32 v220, v251, v220
    v_mul_f32 v221, v251, v221
    v_lshlrev_b32 v124, 16, v247
    v_and_b32 v125, 0xffff0000, v247
    v_pk_mul_f32 v[124:125], v[124:125], v[122:123]
    v_cvt_pk_bf16_f32 v125, v124, v125
    v_lshlrev_b32 v124, 16, v125
    v_and_b32 v125, 0xffff0000, v125
    v_pk_add_f32 v[222:223], v[222:223], v[124:125]
    v_mul_f32 v222, v251, v222
    v_mul_f32 v223, v251, v223
    s_waitcnt lgkmcnt(6)
    v_mfma_f32_16x16x32_bf16 v[176:179], v[104:107], v[72:75], v[176:179]
    v_mfma_f32_16x16x32_bf16 v[180:183], v[104:107], v[76:79], v[180:183]
    ds_read_b64_tr_b16 v[104:105], v120 offset:256
    ds_read_b64_tr_b16 v[106:107], v120 offset:1280
    buffer_load_dwordx4 v[228:231], v11, s[8:11], s96 offen offset:256 sc1
    s_waitcnt lgkmcnt(6)
    v_mfma_f32_16x16x32_bf16 v[188:191], v[108:111], v[76:79], v[188:191]
    v_mfma_f32_16x16x32_bf16 v[184:187], v[108:111], v[72:75], v[184:187]
    ds_read_b64_tr_b16 v[108:109], v126 offset:256
    ds_read_b64_tr_b16 v[110:111], v126 offset:1280
    v_xor_b32 v4, 0x1000, v4
    v_xor_b32 v5, 0x1000, v5
    v_xor_b32 v6, 0x1000, v6
    v_xor_b32 v7, 0x1000, v7
    v_xor_b32 v8, 0x1000, v8
    s_waitcnt vmcnt(4) lgkmcnt(6)
    v_mfma_f32_16x16x32_bf16 v[160:163], v[96:99], v[80:83], v[160:163]
    v_mfma_f32_16x16x32_bf16 v[164:167], v[96:99], v[84:87], v[164:167]
    ds_read_b64_tr_b16 v[96:97], v120 offset:8192
    ds_read_b64_tr_b16 v[98:99], v120 offset:9216
    s_add_u32 s96, s85, 45056
    s_and_b32 s96, s96, 65535
    buffer_load_dwordx4 v[232:235], v11, s[8:11], s96 offen sc1
    s_waitcnt lgkmcnt(6)
    v_mfma_f32_16x16x32_bf16 v[172:175], v[100:103], v[84:87], v[172:175]
    v_mfma_f32_16x16x32_bf16 v[168:171], v[100:103], v[80:83], v[168:171]
    ds_read_b64_tr_b16 v[100:101], v126 offset:8192
    ds_read_b64_tr_b16 v[102:103], v126 offset:9216
    s_waitcnt lgkmcnt(6)
    v_mfma_f32_16x16x32_bf16 v[176:179], v[104:107], v[80:83], v[176:179]
    v_mfma_f32_16x16x32_bf16 v[180:183], v[104:107], v[84:87], v[180:183]
    ds_read_b64_tr_b16 v[104:105], v120 offset:8448
    ds_read_b64_tr_b16 v[106:107], v120 offset:9472
    buffer_load_dwordx4 v[236:239], v11, s[8:11], s96 offen offset:256 sc1
    s_waitcnt lgkmcnt(6)
    v_mfma_f32_16x16x32_bf16 v[188:191], v[108:111], v[84:87], v[188:191]
    v_mfma_f32_16x16x32_bf16 v[184:187], v[108:111], v[80:83], v[184:187]
    ds_read_b64_tr_b16 v[108:109], v126 offset:8448
    ds_read_b64_tr_b16 v[110:111], v126 offset:9472
    s_waitcnt vmcnt(4) lgkmcnt(6)
    v_mfma_f32_16x16x32_bf16 v[160:163], v[96:99], v[88:91], v[160:163]
    v_mfma_f32_16x16x32_bf16 v[164:167], v[96:99], v[92:95], v[164:167]
    ds_read_b64_tr_b16 v[96:97], v120 offset:16384
    ds_read_b64_tr_b16 v[98:99], v120 offset:17408
    s_add_u32 s96, s85, 49152
    s_and_b32 s96, s96, 65535
    buffer_load_dwordx4 v[128:131], v11, s[8:11], s96 offen sc1
    s_waitcnt lgkmcnt(6)
    v_mfma_f32_16x16x32_bf16 v[172:175], v[100:103], v[92:95], v[172:175]
    v_mfma_f32_16x16x32_bf16 v[168:171], v[100:103], v[88:91], v[168:171]
    ds_read_b64_tr_b16 v[100:101], v126 offset:16384
    ds_read_b64_tr_b16 v[102:103], v126 offset:17408
    s_waitcnt lgkmcnt(6)
    v_mfma_f32_16x16x32_bf16 v[176:179], v[104:107], v[88:91], v[176:179]
    v_mfma_f32_16x16x32_bf16 v[180:183], v[104:107], v[92:95], v[180:183]
    ds_read_b64_tr_b16 v[104:105], v120 offset:16640
    ds_read_b64_tr_b16 v[106:107], v120 offset:17664
    buffer_load_dwordx4 v[132:135], v11, s[8:11], s96 offen offset:256 sc1
    s_waitcnt lgkmcnt(6)
    v_mfma_f32_16x16x32_bf16 v[188:191], v[108:111], v[92:95], v[188:191]
    v_mfma_f32_16x16x32_bf16 v[184:187], v[108:111], v[88:91], v[184:187]
    ds_read_b64_tr_b16 v[108:109], v126 offset:16640
    ds_read_b64_tr_b16 v[110:111], v126 offset:17664
    s_waitcnt vmcnt(4) lgkmcnt(6)
    v_mfma_f32_16x16x32_bf16 v[160:163], v[96:99], v[224:227], v[160:163]
    v_mfma_f32_16x16x32_bf16 v[164:167], v[96:99], v[228:231], v[164:167]
    ds_read_b64_tr_b16 v[96:97], v120 offset:24576
    ds_read_b64_tr_b16 v[98:99], v120 offset:25600
    s_add_u32 s96, s85, 53248
    s_and_b32 s96, s96, 65535
    buffer_load_dwordx4 v[136:139], v11, s[8:11], s96 offen sc1
    s_waitcnt lgkmcnt(6)
    v_mfma_f32_16x16x32_bf16 v[172:175], v[100:103], v[228:231], v[172:175]
    v_mfma_f32_16x16x32_bf16 v[168:171], v[100:103], v[224:227], v[168:171]
    ds_read_b64_tr_b16 v[100:101], v126 offset:24576
    ds_read_b64_tr_b16 v[102:103], v126 offset:25600
    s_waitcnt lgkmcnt(6)
    v_mfma_f32_16x16x32_bf16 v[176:179], v[104:107], v[224:227], v[176:179]
    v_mfma_f32_16x16x32_bf16 v[180:183], v[104:107], v[228:231], v[180:183]
    ds_read_b64_tr_b16 v[104:105], v120 offset:24832
    ds_read_b64_tr_b16 v[106:107], v120 offset:25856
    buffer_load_dwordx4 v[140:143], v11, s[8:11], s96 offen offset:256 sc1
    s_waitcnt lgkmcnt(6)
    v_mfma_f32_16x16x32_bf16 v[188:191], v[108:111], v[228:231], v[188:191]
    v_mfma_f32_16x16x32_bf16 v[184:187], v[108:111], v[224:227], v[184:187]
    ds_read_b64_tr_b16 v[108:109], v126 offset:24832
    ds_read_b64_tr_b16 v[110:111], v126 offset:25856
    s_waitcnt vmcnt(4) lgkmcnt(6)
    v_mfma_f32_16x16x32_bf16 v[160:163], v[96:99], v[232:235], v[160:163]
    v_mfma_f32_16x16x32_bf16 v[164:167], v[96:99], v[236:239], v[164:167]
    ds_read_b64_tr_b16 v[96:97], v121 offset:49152
    ds_read_b64_tr_b16 v[98:99], v121 offset:50176
    s_add_u32 s96, s85, 57344
    s_and_b32 s96, s96, 65535
    buffer_load_dwordx4 v[144:147], v11, s[8:11], s96 offen sc1
    s_waitcnt lgkmcnt(6)
    v_mfma_f32_16x16x32_bf16 v[172:175], v[100:103], v[236:239], v[172:175]
    v_mfma_f32_16x16x32_bf16 v[168:171], v[100:103], v[232:235], v[168:171]
    ds_read_b64_tr_b16 v[100:101], v118 offset:49152
    ds_read_b64_tr_b16 v[102:103], v118 offset:50176
    s_waitcnt lgkmcnt(6)
    v_mfma_f32_16x16x32_bf16 v[176:179], v[104:107], v[232:235], v[176:179]
    v_mfma_f32_16x16x32_bf16 v[180:183], v[104:107], v[236:239], v[180:183]
    ds_read_b64_tr_b16 v[104:105], v121 offset:49408
    ds_read_b64_tr_b16 v[106:107], v121 offset:50432
    buffer_load_dwordx4 v[148:151], v11, s[8:11], s96 offen offset:256 sc1
    s_waitcnt lgkmcnt(6)
    v_mfma_f32_16x16x32_bf16 v[188:191], v[108:111], v[236:239], v[188:191]
    v_mfma_f32_16x16x32_bf16 v[184:187], v[108:111], v[232:235], v[184:187]
    ds_read_b64_tr_b16 v[108:109], v118 offset:49408
    ds_read_b64_tr_b16 v[110:111], v118 offset:50432
    s_waitcnt vmcnt(4) lgkmcnt(6)
    v_mfma_f32_16x16x32_bf16 v[160:163], v[96:99], v[128:131], v[160:163]
    v_mfma_f32_16x16x32_bf16 v[164:167], v[96:99], v[132:135], v[164:167]
    ds_read_b64_tr_b16 v[96:97], v121 offset:16384
    ds_read_b64_tr_b16 v[98:99], v121 offset:17408
    s_add_u32 s96, s85, 61440
    s_and_b32 s96, s96, 65535
    buffer_load_dwordx4 v[152:155], v11, s[8:11], s96 offen sc1
    s_waitcnt lgkmcnt(6)
    v_mfma_f32_16x16x32_bf16 v[172:175], v[100:103], v[132:135], v[172:175]
    v_mfma_f32_16x16x32_bf16 v[168:171], v[100:103], v[128:131], v[168:171]
    ds_read_b64_tr_b16 v[100:101], v118 offset:16384
    ds_read_b64_tr_b16 v[102:103], v118 offset:17408
    s_waitcnt lgkmcnt(6)
    v_mfma_f32_16x16x32_bf16 v[176:179], v[104:107], v[128:131], v[176:179]
    v_mfma_f32_16x16x32_bf16 v[180:183], v[104:107], v[132:135], v[180:183]
    ds_read_b64_tr_b16 v[104:105], v121 offset:16640
    ds_read_b64_tr_b16 v[106:107], v121 offset:17664
    buffer_load_dwordx4 v[156:159], v11, s[8:11], s96 offen offset:256 sc1
    s_waitcnt lgkmcnt(6)
    v_mfma_f32_16x16x32_bf16 v[188:191], v[108:111], v[132:135], v[188:191]
    v_mfma_f32_16x16x32_bf16 v[184:187], v[108:111], v[128:131], v[184:187]
    ds_read_b64_tr_b16 v[108:109], v118 offset:16640
    ds_read_b64_tr_b16 v[110:111], v118 offset:17664
    s_waitcnt vmcnt(4) lgkmcnt(6)
    v_mfma_f32_16x16x32_bf16 v[160:163], v[96:99], v[136:139], v[160:163]
    v_mfma_f32_16x16x32_bf16 v[164:167], v[96:99], v[140:143], v[164:167]
    ds_read_b64_tr_b16 v[96:97], v121 offset:57344
    ds_read_b64_tr_b16 v[98:99], v121 offset:58368
    s_waitcnt lgkmcnt(6)
    v_mfma_f32_16x16x32_bf16 v[172:175], v[100:103], v[140:143], v[172:175]
    v_mfma_f32_16x16x32_bf16 v[168:171], v[100:103], v[136:139], v[168:171]
    ds_read_b64_tr_b16 v[100:101], v118 offset:57344
    ds_read_b64_tr_b16 v[102:103], v118 offset:58368
    s_waitcnt lgkmcnt(6)
    v_mfma_f32_16x16x32_bf16 v[176:179], v[104:107], v[136:139], v[176:179]
    v_mfma_f32_16x16x32_bf16 v[180:183], v[104:107], v[140:143], v[180:183]
    ds_read_b64_tr_b16 v[104:105], v121 offset:57600
    ds_read_b64_tr_b16 v[106:107], v121 offset:58624
    s_waitcnt lgkmcnt(6)
    v_mfma_f32_16x16x32_bf16 v[188:191], v[108:111], v[140:143], v[188:191]
    v_mfma_f32_16x16x32_bf16 v[184:187], v[108:111], v[136:139], v[184:187]
    ds_read_b64_tr_b16 v[108:109], v118 offset:57600
    ds_read_b64_tr_b16 v[110:111], v118 offset:58624
    s_waitcnt vmcnt(2) lgkmcnt(6)
    v_mfma_f32_16x16x32_bf16 v[160:163], v[96:99], v[144:147], v[160:163]
    v_mfma_f32_16x16x32_bf16 v[164:167], v[96:99], v[148:151], v[164:167]
    ds_read_b64_tr_b16 v[96:97], v121 offset:24576
    ds_read_b64_tr_b16 v[98:99], v121 offset:25600
    s_waitcnt lgkmcnt(6)
    v_mfma_f32_16x16x32_bf16 v[172:175], v[100:103], v[148:151], v[172:175]
    v_mfma_f32_16x16x32_bf16 v[168:171], v[100:103], v[144:147], v[168:171]
    ds_read_b64_tr_b16 v[100:101], v118 offset:24576
    ds_read_b64_tr_b16 v[102:103], v118 offset:25600
    s_waitcnt lgkmcnt(6)
    v_mfma_f32_16x16x32_bf16 v[176:179], v[104:107], v[144:147], v[176:179]
    v_mfma_f32_16x16x32_bf16 v[180:183], v[104:107], v[148:151], v[180:183]
    ds_read_b64_tr_b16 v[104:105], v121 offset:24832
    ds_read_b64_tr_b16 v[106:107], v121 offset:25856
    s_waitcnt lgkmcnt(6)
    v_mfma_f32_16x16x32_bf16 v[188:191], v[108:111], v[148:151], v[188:191]
    v_mfma_f32_16x16x32_bf16 v[184:187], v[108:111], v[144:147], v[184:187]
    ds_read_b64_tr_b16 v[108:109], v118 offset:24832
    ds_read_b64_tr_b16 v[110:111], v118 offset:25856
    s_waitcnt vmcnt(0) lgkmcnt(6)
    v_mfma_f32_16x16x32_bf16 v[160:163], v[96:99], v[152:155], v[160:163]
    v_mfma_f32_16x16x32_bf16 v[164:167], v[96:99], v[156:159], v[164:167]
    s_waitcnt lgkmcnt(4)
    v_mfma_f32_16x16x32_bf16 v[172:175], v[100:103], v[156:159], v[172:175]
    v_mfma_f32_16x16x32_bf16 v[168:171], v[100:103], v[152:155], v[168:171]
    s_waitcnt lgkmcnt(2)
    v_mfma_f32_16x16x32_bf16 v[176:179], v[104:107], v[152:155], v[176:179]
    v_mfma_f32_16x16x32_bf16 v[180:183], v[104:107], v[156:159], v[180:183]
    s_waitcnt lgkmcnt(0)
    v_mfma_f32_16x16x32_bf16 v[188:191], v[108:111], v[156:159], v[188:191]
    v_mfma_f32_16x16x32_bf16 v[184:187], v[108:111], v[152:155], v[184:187]
    s_nop 7
    s_cmp_lt_u32 s3, 4
    s_cbranch_scc1 L_xs1
    ds_write_b128 v3, v[160:163] offset:0
    ds_write_b128 v3, v[164:167] offset:1024
    ds_write_b128 v3, v[168:171] offset:2048
    ds_write_b128 v3, v[172:175] offset:3072
    v_pk_mov_b32 v[160:161], v[176:177], v[176:177] op_sel:[0,1]
    v_pk_mov_b32 v[162:163], v[178:179], v[178:179] op_sel:[0,1]
    v_pk_mov_b32 v[164:165], v[180:181], v[180:181] op_sel:[0,1]
    v_pk_mov_b32 v[166:167], v[182:183], v[182:183] op_sel:[0,1]
    v_pk_mov_b32 v[168:169], v[184:185], v[184:185] op_sel:[0,1]
    v_pk_mov_b32 v[170:171], v[186:187], v[186:187] op_sel:[0,1]
    v_pk_mov_b32 v[172:173], v[188:189], v[188:189] op_sel:[0,1]
    v_pk_mov_b32 v[174:175], v[190:191], v[190:191] op_sel:[0,1]
    s_branch L_xe1
L_xs1:
    ds_write_b128 v3, v[176:179] offset:0
    ds_write_b128 v3, v[180:183] offset:1024
    ds_write_b128 v3, v[184:187] offset:2048
    ds_write_b128 v3, v[188:191] offset:3072
L_xe1:
    s_waitcnt lgkmcnt(0)
    s_barrier
    ds_read_b128 v[176:179], v2 offset:0
    ds_read_b128 v[180:183], v2 offset:1024
    ds_read_b128 v[184:187], v2 offset:2048
    ds_read_b128 v[188:191], v2 offset:3072
    s_mov_b32 s34, 0x8000
    s_mov_b32 s35, 0x10000
    s_mov_b32 s36, 0x18000
    s_waitcnt lgkmcnt(0)
    v_pk_add_f32 v[160:161], v[160:161], v[176:177]
    v_cvt_pk_bf16_f32 v161, v160, v161
    v_lshlrev_b32 v160, 16, v161
    v_and_b32 v161, 0xffff0000, v161
    v_pk_mul_f32 v[160:161], v[160:161], v[116:117] op_sel:[0,0] op_sel_hi:[1,0]
    v_cvt_pk_bf16_f32 v161, v160, v161
    v_lshlrev_b32 v160, 16, v161
    v_and_b32 v161, 0xffff0000, v161
    v_pk_add_f32 v[162:163], v[162:163], v[178:179]
    v_cvt_pk_bf16_f32 v163, v162, v163
    v_lshlrev_b32 v162, 16, v163
    v_and_b32 v163, 0xffff0000, v163
    v_pk_mul_f32 v[162:163], v[162:163], v[116:117] op_sel:[0,0] op_sel_hi:[1,0]
    v_cvt_pk_bf16_f32 v163, v162, v163
    v_lshlrev_b32 v162, 16, v163
    v_and_b32 v163, 0xffff0000, v163
    ds_write_b128 v4, v[160:163]
    v_pk_add_f32 v[164:165], v[164:165], v[180:181]
    v_cvt_pk_bf16_f32 v165, v164, v165
    v_lshlrev_b32 v164, 16, v165
    v_and_b32 v165, 0xffff0000, v165
    v_pk_mul_f32 v[164:165], v[164:165], v[116:117] op_sel:[0,1] op_sel_hi:[1,1]
    v_cvt_pk_bf16_f32 v165, v164, v165
    v_lshlrev_b32 v164, 16, v165
    v_and_b32 v165, 0xffff0000, v165
    v_pk_add_f32 v[166:167], v[166:167], v[182:183]
    v_cvt_pk_bf16_f32 v167, v166, v167
    v_lshlrev_b32 v166, 16, v167
    v_and_b32 v167, 0xffff0000, v167
    v_pk_mul_f32 v[166:167], v[166:167], v[116:117] op_sel:[0,1] op_sel_hi:[1,1]
    v_cvt_pk_bf16_f32 v167, v166, v167
    v_lshlrev_b32 v166, 16, v167
    v_and_b32 v167, 0xffff0000, v167
    ds_write_b128 v5, v[164:167]
    v_pk_add_f32 v[168:169], v[168:169], v[184:185]
    v_cvt_pk_bf16_f32 v169, v168, v169
    v_lshlrev_b32 v168, 16, v169
    v_and_b32 v169, 0xffff0000, v169
    v_pk_mul_f32 v[168:169], v[168:169], v[116:117] op_sel:[0,0] op_sel_hi:[1,0]
    v_cvt_pk_bf16_f32 v169, v168, v169
    v_lshlrev_b32 v168, 16, v169
    v_and_b32 v169, 0xffff0000, v169
    v_pk_add_f32 v[170:171], v[170:171], v[186:187]
    v_cvt_pk_bf16_f32 v171, v170, v171
    v_lshlrev_b32 v170, 16, v171
    v_and_b32 v171, 0xffff0000, v171
    v_pk_mul_f32 v[170:171], v[170:171], v[116:117] op_sel:[0,0] op_sel_hi:[1,0]
    v_cvt_pk_bf16_f32 v171, v170, v171
    v_lshlrev_b32 v170, 16, v171
    v_and_b32 v171, 0xffff0000, v171
    ds_write_b128 v6, v[168:171]
    v_pk_add_f32 v[172:173], v[172:173], v[188:189]
    v_cvt_pk_bf16_f32 v173, v172, v173
    v_lshlrev_b32 v172, 16, v173
    v_and_b32 v173, 0xffff0000, v173
    v_pk_mul_f32 v[172:173], v[172:173], v[116:117] op_sel:[0,1] op_sel_hi:[1,1]
    v_cvt_pk_bf16_f32 v173, v172, v173
    v_lshlrev_b32 v172, 16, v173
    v_and_b32 v173, 0xffff0000, v173
    v_pk_add_f32 v[174:175], v[174:175], v[190:191]
    v_cvt_pk_bf16_f32 v175, v174, v175
    v_lshlrev_b32 v174, 16, v175
    v_and_b32 v175, 0xffff0000, v175
    v_pk_mul_f32 v[174:175], v[174:175], v[116:117] op_sel:[0,1] op_sel_hi:[1,1]
    v_cvt_pk_bf16_f32 v175, v174, v175
    v_lshlrev_b32 v174, 16, v175
    v_and_b32 v175, 0xffff0000, v175
    ds_write_b128 v7, v[172:175]
    ds_read_b128 v[16:19], v8 offset:0
    ds_read_b128 v[20:23], v8 offset:1024
    ds_read_b128 v[24:27], v8 offset:2048
    ds_read_b128 v[28:31], v8 offset:3072
    s_waitcnt lgkmcnt(3)
    v_pk_add_f32 v[16:17], v[16:17], v[208:209]
    v_pk_add_f32 v[18:19], v[18:19], v[210:211]
    buffer_store_dwordx4 v[16:19], v127, s[20:23], 0 offen
    s_waitcnt lgkmcnt(2)
    v_pk_add_f32 v[20:21], v[20:21], v[212:213]
    v_pk_add_f32 v[22:23], v[22:23], v[214:215]
    buffer_store_dwordx4 v[20:23], v127, s[20:23], s34 offen
    s_waitcnt lgkmcnt(1)
    v_pk_add_f32 v[24:25], v[24:25], v[216:217]
    v_pk_add_f32 v[26:27], v[26:27], v[218:219]
    buffer_store_dwordx4 v[24:27], v127, s[20:23], s35 offen
    s_waitcnt lgkmcnt(0)
    v_pk_add_f32 v[28:29], v[28:29], v[220:221]
    v_pk_add_f32 v[30:31], v[30:31], v[222:223]
    buffer_store_dwordx4 v[28:31], v127, s[20:23], s36 offen
L_end:
L_cend:
    s_endpgm
L_fb:
    s_lshl_b32 s34, s25, 18
    s_add_u32 s34, s34, 1048576
    s_mov_b32 s35, s34
    s_mov_b32 s36, 0
    v_mov_b32 v13, 0xff7fffff
L_fb1:
    buffer_load_dwordx4 v[56:59], v114, s[8:11], s35 offen sc1
    buffer_load_dwordx4 v[60:63], v114, s[8:11], s35 offen offset:1024 sc1
    s_add_u32 s35, s35, 0x1000
    s_add_u32 s36, s36, 1
    s_waitcnt vmcnt(0)
    v_mfma_f32_32x32x16_bf16 v[16:31], v[56:59], v[2:5], 0
    v_mfma_f32_32x32x16_bf16 v[16:31], v[60:63], v[6:9], v[16:31]
    s_nop 11
    v_max3_f32 v13, v16, v17, v13
    v_max3_f32 v13, v18, v19, v13
    v_max3_f32 v13, v20, v21, v13
    v_max3_f32 v13, v22, v23, v13
    v_max3_f32 v13, v24, v25, v13
    v_max3_f32 v13, v26, v27, v13
    v_max3_f32 v13, v28, v29, v13
    v_max3_f32 v13, v30, v31, v13
    s_cmp_lt_u32 s36, 64
    s_cbranch_scc1 L_fb1
    v_mov_b32 v14, v13
    s_nop 1
    v_permlane32_swap_b32 v13, v14
    s_nop 1
    v_max_f32 v13, v13, v14
    v_sub_f32 v32, 0, v13
    v_sub_f32 v33, 0, v13
    v_sub_f32 v34, 0, v13
    v_sub_f32 v35, 0, v13
    v_sub_f32 v36, 0, v13
    v_sub_f32 v37, 0, v13
    v_sub_f32 v38, 0, v13
    v_sub_f32 v39, 0, v13
    v_sub_f32 v40, 0, v13
    v_sub_f32 v41, 0, v13
    v_sub_f32 v42, 0, v13
    v_sub_f32 v43, 0, v13
    v_sub_f32 v44, 0, v13
    v_sub_f32 v45, 0, v13
    v_sub_f32 v46, 0, v13
    v_sub_f32 v47, 0, v13
    v_mov_b32 v72, 0
    v_mov_b32 v73, 0
    v_mov_b32 v74, 0
    v_mov_b32 v75, 0
    v_mov_b32 v76, 0
    v_mov_b32 v77, 0
    v_mov_b32 v78, 0
    v_mov_b32 v79, 0
    v_mov_b32 v80, 0
    v_mov_b32 v81, 0
    v_mov_b32 v82, 0
    v_mov_b32 v83, 0
    v_mov_b32 v84, 0
    v_mov_b32 v85, 0
    v_mov_b32 v86, 0
    v_mov_b32 v87, 0
    v_mov_b32 v88, 0
    v_mov_b32 v89, 0
    v_mov_b32 v90, 0
    v_mov_b32 v91, 0
    s_mov_b32 s36, 0
L_fb2:
    buffer_load_dwordx4 v[56:59], v114, s[8:11], s34 offen sc1
    buffer_load_dwordx4 v[60:63], v114, s[8:11], s34 offen offset:1024 sc1
    buffer_load_dwordx4 v[64:67], v114, s[8:11], s34 offen offset:2048 sc1
    buffer_load_dwordx4 v[68:71], v114, s[8:11], s34 offen offset:3072 sc1
    s_add_u32 s34, s34, 0x1000
    s_add_u32 s36, s36, 1
    s_waitcnt vmcnt(0)
    v_mfma_f32_32x32x16_bf16 v[16:31], v[56:59], v[2:5], v[32:47]
    v_mfma_f32_32x32x16_bf16 v[16:31], v[60:63], v[6:9], v[16:31]
    s_nop 11
    v_exp_f32 v16, v16
    v_exp_f32 v17, v17
    v_exp_f32 v18, v18
    v_exp_f32 v19, v19
    v_exp_f32 v20, v20
    v_exp_f32 v21, v21
    v_exp_f32 v22, v22
    v_exp_f32 v23, v23
    v_exp_f32 v24, v24
    v_exp_f32 v25, v25
    v_exp_f32 v26, v26
    v_exp_f32 v27, v27
    v_exp_f32 v28, v28
    v_exp_f32 v29, v29
    v_exp_f32 v30, v30
    v_exp_f32 v31, v31
    v_cvt_pk_bf16_f32 v48, v16, v17
    v_cvt_pk_bf16_f32 v49, v18, v19
    v_cvt_pk_bf16_f32 v50, v20, v21
    v_cvt_pk_bf16_f32 v51, v22, v23
    v_cvt_pk_bf16_f32 v52, v24, v25
    v_cvt_pk_bf16_f32 v53, v26, v27
    v_cvt_pk_bf16_f32 v54, v28, v29
    v_cvt_pk_bf16_f32 v55, v30, v31
    v_mfma_f32_32x32x16_bf16 v[72:87], v[64:67], v[48:51], v[72:87]
    s_nop 0
    v_smfmac_f32_16x16x64_bf16 v[88:91], v[92:95], v[48:55], v0
    v_mfma_f32_32x32x16_bf16 v[72:87], v[68:71], v[52:55], v[72:87]
    s_nop 7
    s_nop 7
    s_cmp_lt_u32 s36, 64
    s_cbranch_scc1 L_fb2
    v_add_f32 v88, v88, v89
    v_mov_b32 v90, v88
    s_branch L_fbret
.section .rodata,"a"
.p2align 6
.amdhsa_kernel gated_mix__ssm_conv_s5__softmax_full_mha__prompt_kernel
  .amdhsa_next_free_vgpr 256
  .amdhsa_next_free_sgpr 102
  .amdhsa_accum_offset 256
  .amdhsa_group_segment_fixed_size 0
  .amdhsa_kernarg_size 128
  .amdhsa_user_sgpr_count 2
  .amdhsa_user_sgpr_kernarg_segment_ptr 1
  .amdhsa_system_sgpr_workgroup_id_x 1
.end_amdhsa_kernel
```
